```python
import torch

def _softmax(x, axis=-1):
    return torch.softmax(x, dim=axis)
def _gelu(x):
    return torch.nn.functional.gelu(x, approximate="tanh")
def _silu(x):
    return torch.nn.functional.silu(x)
def _sigmoid(x):
    return torch.sigmoid(x)
def _layernorm(x, axis=-1, eps=1e-5):
    m = x.mean(dim=axis, keepdim=True)
    v = x.var(dim=axis, keepdim=True, unbiased=False)
    return (x - m) / torch.sqrt(v + eps)
def _scatter_add(tgt, idx, src, axis=0):
    return tgt.clone().index_add_(axis, idx, src)
def _segment_sum(src, seg, n):
    out = torch.zeros((n,) + src.shape[1:], dtype=src.dtype)
    return out.index_add_(0, seg, src)
def _pad(x, pw):
    flat = tuple(v for pair in reversed(pw) for v in pair)
    return torch.nn.functional.pad(x, flat)

kernel_name = 'gather_scatter__mpnn_edge_mlp__graph'

def setup_inputs():

    _w = (lambda a: (lambda t: t.to(torch.bfloat16) if t.is_floating_point() else t)(torch.as_tensor(a)))
    N, deg, D, De = 10000, 32, 128, max(4, 1)
    E = N * deg
    return {
        "x": _w((lambda *s: torch.randn(*s, dtype=torch.bfloat16) * 0.05)(N, D)),
        "e_attr": _w((lambda *s: torch.randn(*s, dtype=torch.bfloat16) * 0.4)(E, De)),
        "src": _w((lambda lo, hi, *s: torch.randint(lo, hi, s))(0, N, E).to(torch.int64)),
        "dst": _w((lambda lo, hi, *s: torch.randint(lo, hi, s))(0, N, E).to(torch.int64)),
        "w_msg": _w((lambda *s: torch.randn(*s, dtype=torch.bfloat16) * 0.4)(2 * D + De, D)),
        "w_upd": _w((lambda *s: torch.randn(*s, dtype=torch.bfloat16) * 0.05)(2 * D, D)),
    }

def reference(x, e_attr, src, dst, w_msg, w_upd):
    N, D = x.shape
    m_in = torch.concatenate([x[src], x[dst], e_attr], axis=-1)
    msg = _silu(m_in @ w_msg)
    agg = _segment_sum(msg, dst, N)
    return _silu(torch.concatenate([x, agg], axis=-1) @ w_upd)
```

```asm
; @launch kernel=mpnn_bin_kernel grid=(512,1,1) block=(768,1,1) lds=67584
; @launch kernel=mpnn_edge_kernel grid=(256,1,1) block=(1024,1,1) lds=141568
.amdgcn_target "amdgcn-amd-amdhsa--gfx950"
.text
.globl mpnn_bin_kernel
.p2align 8
.type mpnn_bin_kernel,@function
mpnn_bin_kernel:
    s_load_dwordx4 s[8:11], s[0:1], 16
    s_load_dwordx4 s[4:7], s[0:1], 0
    s_load_dwordx4 s[12:15], s[0:1], 32
    s_load_dwordx2 s[16:17], s[0:1], 64
    s_cmp_ge_u32 s2, 512
    s_cbranch_scc1 K1_END
    v_lshrrev_b32 v2, 6, v0
    v_and_b32 v1, 63, v0
    v_readfirstlane_b32 s21, v2
    s_and_b32 s20, s2, 7
    s_lshl_b32 s20, s20, 5
    s_lshr_b32 s3, s2, 4
    s_or_b32 s20, s20, s3
    s_lshr_b32 s3, s2, 5
    s_xor_b32 s3, s3, s2
    s_bitcmp0_b32 s3, 3
    s_cbranch_scc1 K1_BIN
    s_lshr_b32 s20, s2, 4
    s_lshl_b32 s20, s20, 3
    s_and_b32 s3, s2, 7
    s_or_b32 s20, s20, s3
    v_lshrrev_b32 v2, 4, v1
    v_and_b32 v3, 15, v1
    s_cmp_ge_u32 s20, 209
    s_cbranch_scc1 K1_JOBS
    v_lshrrev_b32 v5, 4, v0
    v_xor_b32 v6, v5, v0
    v_and_b32 v6, 15, v6
    s_mul_i32 s25, s20, 48
    v_add_u32 v5, s25, v5
    v_lshlrev_b32 v5, 8, v5
    v_lshl_or_b32 v5, v6, 4, v5
    s_lshl_b32 s27, s21, 10
    s_add_u32 s28, s27, 32768
    s_mov_b32 m0, s28
    v_lshlrev_b32 v4, 1, v2
    v_xor_b32 v4, v4, v3
    v_lshlrev_b32 v4, 4, v4
    v_lshl_or_b32 v4, v2, 8, v4
    s_lshl_b32 s28, s21, 6
    s_and_b32 s28, s28, 0x80
    v_xor_b32 v4, s28, v4
    s_waitcnt lgkmcnt(0)
    s_mov_b32 s6, 0x271000
    s_mov_b32 s7, 0x20000
    s_mov_b32 s14, 0x8000
    s_mov_b32 s15, 0x20000
    buffer_load_dwordx4 v5, s[4:7], 0 offen lds
    s_mov_b32 m0, s27
    s_nop 0
    buffer_load_dwordx4 v4, s[12:15], s27 offen lds
    s_add_u32 s27, s27, 12288
    s_mov_b32 m0, s27
    s_nop 0
    buffer_load_dwordx4 v4, s[12:15], s27 offen lds
    s_add_u32 s27, s27, 12288
    s_cmp_ge_u32 s21, 8
    s_cbranch_scc1 K1_DMAD
    s_mov_b32 m0, s27
    s_nop 0
    buffer_load_dwordx4 v4, s[12:15], s27 offen lds
    s_branch K1_DMAD
K1_BIN:
    s_cmp_ge_u32 s21, 10
    s_cbranch_scc1 K1_END
    s_mul_i32 s22, s20, 5000
    s_lshl_b32 s23, s22, 1
    v_lshlrev_b32 v3, 3, v0
    v_lshlrev_b32 v4, 4, v0
    v_cmp_gt_u32 vcc, 625, v0
    s_mov_b32 s26, 0x138800
    s_mov_b32 s27, 0x20000
    s_mov_b64 s[44:45], vcc
    s_mov_b64 exec, vcc
    s_waitcnt lgkmcnt(0)
    s_mov_b32 s24, s10
    s_mov_b32 s25, s11
    buffer_load_dwordx2 v[6:7], v3, s[24:27], s22 offen nt
    s_mov_b32 s10, 0x138800
    s_mov_b32 s11, 0x20000
    s_mov_b32 s32, s6
    s_mov_b32 s33, s7
    s_mov_b32 s34, 0x271000
    s_mov_b32 s35, 0x20000
    s_mov_b64 exec, -1
    v_mov_b64 v[20:21], 0
    v_mov_b64 v[22:23], 0
    s_cmp_lg_u32 s21, 0
    s_cbranch_scc1 K1_NOZ
    ds_write_b128 v4, v[20:23] offset:0
K1_NOZ:
    s_waitcnt lgkmcnt(0)
    s_barrier
    s_mov_b64 exec, s[44:45]
    buffer_load_dwordx2 v[8:9], v3, s[8:11], s22 offen nt
    buffer_load_dwordx4 v[10:13], v4, s[32:35], s23 offen nt
    s_mov_b64 exec, -1
    v_mov_b32 v24, 1
    v_lshlrev_b32 v5, 4, v1
    s_mov_b32 s18, 0x6a8800
    s_mov_b32 s19, 0x20000
    s_mul_i32 s38, s20, 15488
    s_add_u32 s38, s38, 2883584
    s_add_u32 s39, s38, 10240
    s_mov_b64 exec, s[44:45]
    s_waitcnt vmcnt(2)
    v_lshlrev_b32 v14, 2, v6
    v_lshlrev_b32 v15, 2, v7
    v_and_b32 v14, 0x3fc, v14
    v_and_b32 v15, 0x3fc, v15
    ds_add_rtn_u32 v16, v14, v24 offset:0
    ds_add_rtn_u32 v17, v15, v24 offset:0
    v_lshrrev_b32 v6, 8, v6
    v_lshrrev_b32 v7, 8, v7
    v_lshlrev_b32 v6, 26, v6
    v_lshlrev_b32 v7, 26, v7
    s_mov_b64 exec, -1
    s_waitcnt lgkmcnt(0)
    s_barrier
    ds_read_b128 v[20:23], v5 offset:0
    s_waitcnt lgkmcnt(0)
    v_add_u32 v25, v20, v21
    v_add_u32 v26, v25, v22
    v_add_u32 v27, v26, v23
    s_nop 1
    v_add_u32_dpp v28, v27, v27 row_shr:1 row_mask:0xf bank_mask:0xf bound_ctrl:1
    s_nop 1
    v_add_u32_dpp v28, v28, v28 row_shr:2 row_mask:0xf bank_mask:0xf
    s_nop 1
    v_add_u32_dpp v28, v28, v28 row_shr:4 row_mask:0xf bank_mask:0xf
    s_nop 1
    v_add_u32_dpp v28, v28, v28 row_shr:8 row_mask:0xf bank_mask:0xf
    s_nop 1
    v_add_u32_dpp v28, v28, v28 row_bcast:15 row_mask:0xa bank_mask:0xf
    s_nop 1
    v_add_u32_dpp v28, v28, v28 row_bcast:31 row_mask:0xc bank_mask:0xf
    v_sub_u32 v28, v28, v27
    v_add_u32 v29, v28, v20
    v_add_u32 v30, v28, v25
    v_add_u32 v31, v28, v26
    ds_write_b128 v5, v[28:31] offset:1024
    ds_read_b32 v18, v14 offset:1024
    ds_read_b32 v19, v15 offset:1024
    s_waitcnt vmcnt(1)
    v_lshl_or_b32 v8, v8, 3, v6
    v_lshl_or_b32 v9, v9, 3, v7
    s_mov_b64 exec, s[44:45]
    s_waitcnt lgkmcnt(0)
    v_add_u32 v18, v18, v16
    v_add_u32 v19, v19, v17
    v_mul_u32_u24 v18, 12, v18
    v_mul_u32_u24 v19, 12, v19
    ds_write_b32 v18, v8 offset:2056
    ds_write_b32 v19, v9 offset:2056
    v_add_u32 v18, 2048, v18
    v_add_u32 v19, 2048, v19
    s_waitcnt vmcnt(0)
    ds_write2_b32 v18, v10, v11 offset0:0 offset1:1
    ds_write2_b32 v19, v12, v13 offset0:0 offset1:1
    s_mov_b64 exec, -1
    s_cmp_lg_u32 s21, 9
    s_cbranch_scc1 K1_NOD
    v_lshl_or_b32 v32, v20, 16, v28
    v_lshl_or_b32 v33, v21, 16, v29
    v_lshl_or_b32 v34, v22, 16, v30
    v_lshl_or_b32 v35, v23, 16, v31
    s_lshl_b32 s36, s20, 4
    s_add_u32 s36, s36, 2621440
    v_and_b32 v36, 7, v1
    v_lshrrev_b32 v37, 3, v1
    v_lshl_or_b32 v36, v36, 3, v37
    v_lshlrev_b32 v36, 12, v36
    buffer_store_dwordx4 v[32:35], v36, s[16:19], s36 offen
K1_NOD:
    s_waitcnt lgkmcnt(0)
    s_barrier
    ds_read_b128 v[20:23], v4 offset:2048
    s_cmp_ge_u32 s21, 5
    s_cbranch_scc1 K1_C1
    ds_read_b128 v[24:27], v4 offset:12288
    s_waitcnt lgkmcnt(0)
    buffer_store_dwordx4 v[24:27], v4, s[16:19], s39 offen
K1_C1:
    s_waitcnt lgkmcnt(0)
    buffer_store_dwordx4 v[20:23], v4, s[16:19], s38 offen
    s_endpgm
K1_DMAD:
    s_mov_b32 s18, 0x271000
    s_mov_b32 s19, 0x20000
    s_lshr_b32 s23, s21, 2
    s_and_b32 s24, s21, 3
    v_lshrrev_b32 v24, 2, v3
    v_and_b32 v25, 3, v3
    v_and_b32 v26, 1, v2
    v_lshl_or_b32 v26, v26, 2, v24
    v_lshl_add_u32 v27, v2, 3, v24
    v_lshlrev_b32 v27, 8, v27
    v_lshl_or_b32 v27, v25, 3, v27
    s_lshl_b32 s27, s24, 1
    v_xor_b32 v26, s27, v26
    v_lshl_add_u32 v28, v26, 5, v27
    v_xor_b32 v29, 32, v28
    v_xor_b32 v30, v2, v3
    v_lshlrev_b32 v30, 4, v30
    v_lshl_or_b32 v30, v3, 8, v30
    s_lshl_b32 s27, s23, 12
    s_add_u32 s27, s27, 32768
    v_add_u32 v30, s27, v30
    v_xor_b32 v31, 64, v30
    v_xor_b32 v32, 0x80, v30
    v_xor_b32 v33, 0xc0, v30
    s_lshl_b32 s26, s23, 4
    s_add_u32 s25, s25, s26
    v_add_u32 v5, s25, v3
    v_lshlrev_b32 v5, 8, v5
    v_lshl_or_b32 v5, v2, 4, v5
    s_lshl_b32 s27, s24, 6
    v_add_u32 v5, s27, v5
    s_mov_b32 s28, 0xbfb8aa3b
    s_waitcnt vmcnt(0)
    s_barrier
    ds_read_b128 v[8:11], v30
    ds_read_b64_tr_b16 v[36:37], v28 offset:0
    ds_read_b64_tr_b16 v[38:39], v28 offset:1024
    ds_read_b64_tr_b16 v[52:53], v29 offset:0
    ds_read_b64_tr_b16 v[54:55], v29 offset:1024
    ds_read_b128 v[12:15], v31
    ds_read_b64_tr_b16 v[40:41], v28 offset:8192
    ds_read_b64_tr_b16 v[42:43], v28 offset:9216
    ds_read_b64_tr_b16 v[56:57], v29 offset:8192
    ds_read_b64_tr_b16 v[58:59], v29 offset:9216
    ds_read_b128 v[16:19], v32
    ds_read_b64_tr_b16 v[44:45], v28 offset:16384
    ds_read_b64_tr_b16 v[46:47], v28 offset:17408
    ds_read_b64_tr_b16 v[60:61], v29 offset:16384
    ds_read_b64_tr_b16 v[62:63], v29 offset:17408
    ds_read_b128 v[20:23], v33
    ds_read_b64_tr_b16 v[48:49], v28 offset:24576
    ds_read_b64_tr_b16 v[50:51], v28 offset:25600
    ds_read_b64_tr_b16 v[64:65], v29 offset:24576
    ds_read_b64_tr_b16 v[66:67], v29 offset:25600
    s_waitcnt lgkmcnt(15)
    v_mfma_f32_16x16x32_bf16 v[68:71], v[36:39], v[8:11], 0
    s_waitcnt lgkmcnt(15)
    v_mfma_f32_16x16x32_bf16 v[72:75], v[52:55], v[8:11], 0
    s_waitcnt lgkmcnt(12)
    v_mfma_f32_16x16x32_bf16 v[68:71], v[40:43], v[12:15], v[68:71]
    s_waitcnt lgkmcnt(10)
    v_mfma_f32_16x16x32_bf16 v[72:75], v[56:59], v[12:15], v[72:75]
    s_waitcnt lgkmcnt(7)
    v_mfma_f32_16x16x32_bf16 v[68:71], v[44:47], v[16:19], v[68:71]
    s_waitcnt lgkmcnt(5)
    v_mfma_f32_16x16x32_bf16 v[72:75], v[60:63], v[16:19], v[72:75]
    s_waitcnt lgkmcnt(2)
    v_mfma_f32_16x16x32_bf16 v[68:71], v[48:51], v[20:23], v[68:71]
    s_waitcnt lgkmcnt(0)
    v_mfma_f32_16x16x32_bf16 v[72:75], v[64:67], v[20:23], v[72:75]
    s_nop 5
    v_pk_mul_f32 v[68:69], v[68:69], s[28:29] op_sel_hi:[1,0]
    v_pk_mul_f32 v[70:71], v[70:71], s[28:29] op_sel_hi:[1,0]
    v_cvt_pk_bf16_f32 v76, v68, v69
    v_cvt_pk_bf16_f32 v77, v70, v71
    v_pk_mul_f32 v[72:73], v[72:73], s[28:29] op_sel_hi:[1,0]
    v_pk_mul_f32 v[74:75], v[74:75], s[28:29] op_sel_hi:[1,0]
    v_cvt_pk_bf16_f32 v78, v72, v73
    v_cvt_pk_bf16_f32 v79, v74, v75
    buffer_store_dwordx4 v[76:79], v5, s[16:19], 0 offen
    s_endpgm
K1_JOBS:
    s_sub_u32 s23, s20, 209
    s_mul_i32 s23, s23, 12
    s_add_u32 s23, s23, s21
    s_waitcnt lgkmcnt(0)
    s_mov_b32 s18, 0x6a8800
    s_mov_b32 s19, 0x20000
    s_cmp_ge_u32 s23, 96
    s_cbranch_scc1 K1_JOB2
    s_lshr_b32 s24, s23, 5
    s_bfe_u32 s25, s23, 0x30002
    s_and_b32 s26, s23, 3
    s_cmp_eq_u32 s24, 0
    s_cselect_b32 s28, s12, s14
    s_cselect_b32 s29, s13, s15
    s_mov_b32 s30, 65536
    s_mov_b32 s31, 0x20000
    s_lshl_b32 s33, s25, 4
    v_add_u32 v4, s33, v3
    v_lshlrev_b32 v4, 1, v4
    s_cmp_eq_u32 s24, 2
    s_cselect_b32 s32, 10, 11
    s_movk_i32 s33, 1024
    s_cmovk_i32 s33, 4096
    s_cselect_b32 s34, 0xb0000000, 1.0
    v_lshlrev_b32 v5, s32, v2
    v_add_u32 v4, v4, v5
    s_lshl_b32 s40, s26, 13
    s_cmp_eq_u32 s24, 1
    s_cselect_b32 s36, 0, 0x8000
    s_add_u32 s40, s40, s36
    s_add_u32 s41, s40, 512
    s_add_u32 s42, s40, s33
    s_add_u32 s43, s42, 512
    buffer_load_ushort v8, v4, s[28:31], s40 offen offset:0
    buffer_load_ushort v9, v4, s[28:31], s40 offen offset:256
    buffer_load_ushort v10, v4, s[28:31], s41 offen offset:0
    buffer_load_ushort v11, v4, s[28:31], s41 offen offset:256
    buffer_load_ushort v12, v4, s[28:31], s42 offen offset:0
    buffer_load_ushort v13, v4, s[28:31], s42 offen offset:256
    buffer_load_ushort v14, v4, s[28:31], s43 offen offset:0
    buffer_load_ushort v15, v4, s[28:31], s43 offen offset:256
    s_lshl_b32 s37, s23, 10
    s_add_u32 s37, s37, 6881280
    v_lshlrev_b32 v6, 4, v1
    s_mov_b32 s38, 0x07060302
    s_waitcnt vmcnt(0)
    v_lshlrev_b32 v8, 16, v8
    v_mul_f32 v8, s34, v8
    v_lshlrev_b32 v9, 16, v9
    v_mul_f32 v9, s34, v9
    v_lshlrev_b32 v10, 16, v10
    v_mul_f32 v10, s34, v10
    v_lshlrev_b32 v11, 16, v11
    v_mul_f32 v11, s34, v11
    v_lshlrev_b32 v12, 16, v12
    v_mul_f32 v12, s34, v12
    v_lshlrev_b32 v13, 16, v13
    v_mul_f32 v13, s34, v13
    v_lshlrev_b32 v14, 16, v14
    v_mul_f32 v14, s34, v14
    v_lshlrev_b32 v15, 16, v15
    v_mul_f32 v15, s34, v15
    v_perm_b32 v16, v9, v8, s38
    v_perm_b32 v17, v11, v10, s38
    v_perm_b32 v18, v13, v12, s38
    v_perm_b32 v19, v15, v14, s38
    buffer_store_dwordx4 v[16:19], v6, s[16:19], s37 offen
    s_endpgm
K1_JOB2:
    s_cmp_ge_u32 s23, 98
    s_cbranch_scc1 K1_JOB3
    s_sub_u32 s24, s23, 96
    s_mov_b32 s14, 66560
    s_mov_b32 s15, 0x20000
    v_and_b32 v2, 31, v1
    v_lshrrev_b32 v3, 5, v1
    v_lshl_or_b32 v2, v2, 1, v3
    v_and_b32 v4, 0x23, v2
    v_bfe_u32 v5, v2, 2, 1
    v_lshl_or_b32 v4, v5, 4, v4
    v_bfe_u32 v5, v2, 3, 2
    v_lshl_or_b32 v4, v5, 2, v4
    v_lshlrev_b32 v4, 1, v4
    s_lshl_b32 s25, s24, 7
    s_add_u32 s25, s25, 65536
    buffer_load_ushort v8, v4, s[12:15], s25 offen offset:0
    buffer_load_ushort v9, v4, s[12:15], s25 offen offset:256
    buffer_load_ushort v10, v4, s[12:15], s25 offen offset:512
    buffer_load_ushort v11, v4, s[12:15], s25 offen offset:768
    s_lshl_b32 s37, s24, 10
    s_add_u32 s37, s37, 6979584
    v_lshlrev_b32 v6, 4, v1
    s_mov_b32 s34, 0xbfb8aa3b
    s_waitcnt vmcnt(0)
    v_lshlrev_b32 v8, 16, v8
    v_mul_f32 v8, s34, v8
    v_lshlrev_b32 v9, 16, v9
    v_mul_f32 v9, s34, v9
    v_lshlrev_b32 v10, 16, v10
    v_mul_f32 v10, s34, v10
    v_lshlrev_b32 v11, 16, v11
    v_mul_f32 v11, s34, v11
    v_cvt_pk_bf16_f32 v16, v8, v9
    v_cvt_pk_bf16_f32 v17, v10, v11
    v_lshlrev_b32 v12, 16, v16
    v_and_b32 v13, 0xffff0000, v16
    v_lshlrev_b32 v14, 16, v17
    v_and_b32 v15, 0xffff0000, v17
    v_sub_f32 v8, v8, v12
    v_sub_f32 v9, v9, v13
    v_sub_f32 v10, v10, v14
    v_sub_f32 v11, v11, v15
    v_cvt_pk_bf16_f32 v18, v8, v9
    v_cvt_pk_bf16_f32 v19, v10, v11
    buffer_store_dwordx4 v[16:19], v6, s[16:19], s37 offen
    s_endpgm
K1_JOB3:
    s_cmp_ge_u32 s20, 224
    s_cbranch_scc1 K1_SPARE
    s_cmp_lg_u32 s23, 98
    s_cbranch_scc1 K1_END
    v_mov_b32 v8, 0
    v_lshlrev_b32 v6, 2, v1
    s_mov_b32 s37, 2560000
    buffer_store_dword v8, v6, s[16:19], s37 offen
K1_END:
    s_endpgm
K1_SPARE:
    s_getpc_b64 s[24:25]
K1_PC:
    s_bfe_u32 s22, s20, 0x20003
    s_mul_i32 s22, s22, 12
    s_add_u32 s22, s22, s21
    s_mul_i32 s22, s22, 384
    v_lshl_add_u32 v2, v1, 6, s22
    v_min_u32 v2, K2_LAST - mpnn_edge_kernel, v2
    v_add_u32 v2, mpnn_edge_kernel - K1_PC, v2
    v_mov_b32 v3, s25
    v_add_co_u32 v2, vcc, s24, v2
    s_nop 1
    v_addc_co_u32 v3, vcc, 0, v3, vcc
    s_bfm_b64 exec, 6, 0
    global_load_dword v4, v[2:3], off
    s_endpgm
.text
.globl mpnn_edge_kernel
.p2align 8
.type mpnn_edge_kernel,@function
mpnn_edge_kernel:
    s_load_dwordx2 s[4:5], s[0:1], 64
    s_load_dwordx2 s[12:13], s[0:1], 0
    s_load_dwordx2 s[16:17], s[0:1], 48
    s_cmp_ge_u32 s2, 256
    s_cbranch_scc1 K2_END
    v_lshrrev_b32 v2, 6, v0
    s_and_b32 s34, s2, 63
    v_readfirstlane_b32 s21, v2
    s_lshl_b32 s34, s34, 10
    s_lshr_b32 s3, s2, 6
    s_add_u32 s34, s34, s3
    s_lshl2_add_u32 s34, s34, 2621440
    s_mov_b32 s6, 0x6a8800
    s_mov_b32 s7, 0x20000
    v_and_b32 v4, -4, v0
    v_lshlrev_b32 v4, 2, v4
    s_waitcnt lgkmcnt(0)
    buffer_load_dword v2, v4, s[4:7], s34 offen
    s_and_b32 s20, s2, 7
    s_bfe_u32 s35, s2, 0x30003
    s_lshl3_add_u32 s20, s20, s35
    s_lshl2_add_u32 s20, s20, s3
K2_NOX:
    v_lshrrev_b32 v3, 2, v0
    v_mul_u32_u24 v3, 15488, v3
    v_and_b32 v4, 3, v0
    s_mov_b32 s24, 0
    s_mov_b32 s25, 24
    s_mov_b32 s56, 1
    v_lshlrev_b32 v56, 4, v0
    v_mov_b64 v[8:9], 0
    v_mov_b64 v[10:11], 0
    s_cmp_ge_u32 s21, 2
    s_cbranch_scc1 K2_NOZ0
    ds_write_b128 v56, v[8:11] offset:0
K2_NOZ0:
    v_add_u32 v57, 71312, v56
    ds_write_b128 v57, v[8:11]
    ds_write_b128 v57, v[8:11] offset:16384
    s_cmp_ge_u32 s21, 11
    s_cbranch_scc1 K2_NOZ3
    ds_write_b128 v57, v[8:11] offset:32768
K2_NOZ3:
    s_waitcnt vmcnt(0)
K2_ROUND:
    s_setprio 2
    v_lshrrev_b32 v16, 16, v2
    v_and_b32 v17, 0xffff, v2
    v_subrev_u32 v16, s24, v16
    v_add3_u32 v17, v17, s24, v4
    v_min_i32 v18, s25, v16
    v_mad_u32_u24 v17, v17, 12, v3
    v_sub_u32 v18, v18, v4
    s_mov_b32 s34, 2883584
    v_cmp_lt_i32 s[40:41], 0, v18
    v_cmp_lt_i32 s[42:43], 4, v18
    v_cmp_lt_i32 s[44:45], 8, v18
    v_cmp_lt_i32 s[46:47], 12, v18
    s_mov_b64 exec, s[40:41]
    buffer_load_dwordx3 v[60:62], v17, s[4:7], s34 offen offset:0
    s_mov_b64 exec, s[42:43]
    buffer_load_dwordx3 v[64:66], v17, s[4:7], s34 offen offset:48
    s_mov_b64 exec, s[44:45]
    s_cbranch_execz K2_RLD
    buffer_load_dwordx3 v[68:70], v17, s[4:7], s34 offen offset:96
    s_mov_b64 exec, s[46:47]
    s_cbranch_execz K2_RLD
    buffer_load_dwordx3 v[72:74], v17, s[4:7], s34 offen offset:144
    v_cmp_lt_i32 s[48:49], 16, v18
    s_mov_b64 exec, s[48:49]
    s_cbranch_execz K2_RLD
    buffer_load_dwordx3 v[76:78], v17, s[4:7], s34 offen offset:192
    v_cmp_lt_i32 s[50:51], 20, v18
    s_mov_b64 exec, s[50:51]
    s_cbranch_execz K2_RLD
    buffer_load_dwordx3 v[80:82], v17, s[4:7], s34 offen offset:240
K2_RLD:
    s_mov_b64 exec, -1
    s_setprio 0
    v_and_b32 v1, 63, v0
    v_cmp_lt_i32 s[58:59], s25, v16
    v_lshlrev_b32 v7, 4, v1
    s_mov_b32 s75, 0
    ds_write_b128 v56, v[8:11] offset:10240
    s_cmp_ge_u32 s21, 8
    s_cbranch_scc1 K2_NOSO
    v_mov_b32 v12, 80000
    v_mov_b32 v13, v12
    v_mov_b32 v14, v12
    v_mov_b32 v15, v12
    ds_write_b128 v56, v[12:15] offset:2048
    s_branch K2_NOW2
K2_NOSO:
    s_mov_b32 s75, s56
K2_NOW2:
    s_cmp_eq_u32 s56, 0
    s_cbranch_scc1 K2_SETD
    v_lshrrev_b32 v5, 4, v1
    v_and_b32 v6, 15, v1
    v_mov_b32 v126, 0
    s_cmp_lt_u32 s20, 16
    s_cselect_b32 s22, 40, 39
    s_bfm_b64 s[78:79], s22, 0
    s_and_b32 s23, s21, 1
    s_lshr_b32 s76, s21, 1
    s_mov_b32 s26, 0x3038aa3b
    s_mov_b32 s68, 0
    s_mov_b32 s52, 0x1f800000
    s_mov_b32 s53, s52
    s_mov_b32 s70, 0x4eb17218
    s_mov_b32 s72, 0xbfb8aa3b
    s_lshl_b32 s39, s23, 7
    s_add_u32 s8, s4, s39
    s_addc_u32 s9, s5, 0
    s_or_b32 s9, s9, 0x80000000
    s_mov_b32 s10, 0x10000
    s_mov_b32 s11, 0x00c00000
    s_mov_b32 s18, 0x271000
    s_mov_b32 s19, 0x20000
K2_SETD:
    v_mov_b32 v59, 4
    v_lshlrev_b32 v58, 2, v1
    v_mov_b32 v124, 1040
    v_and_b32 v91, 31, v1
    s_lshl_b32 s36, s23, 9
    s_add_u32 s37, s36, 28672
    v_lshl_add_u32 v90, v91, 4, s37
    v_lshl_add_u32 v125, s36, 1, v7
    s_movk_i32 s36, 0x3f80
    s_mov_b32 s37, 0
    v_and_b32 v16, 0x30, v7
    v_lshlrev_b64 v[84:85], v16, s[36:37]
    v_mov_b32 v123, 0
    v_mov_b64 v[88:89], 0
    v_mov_b32 v57, 0
    s_mov_b64 exec, s[78:79]
    v_mov_b32 v123, 16
    s_mov_b32 exec_lo, 0x55555555
    s_mov_b32 exec_hi, 0xaaaaaaaa
    v_and_b32 v88, 0x18, v1
    v_mov_b32 v89, 1
    v_bfe_u32 v57, v1, 1, 2
    s_cmp_eq_u32 s75, 0
    s_cbranch_scc1 K2_W0
    s_mov_b64 exec, -1
    v_xor_b32 v108, v5, v6
    v_lshlrev_b32 v108, 4, v108
    v_lshl_or_b32 v108, v6, 8, v108
    v_add_u32 v108, 115456, v108
    v_xor_b32 v109, 64, v108
    v_xor_b32 v110, 0x80, v108
    v_xor_b32 v111, 0xc0, v108
    s_bfe_u32 s36, s21, 0x20001
    s_lshl3_add_u32 s36, s36, s23
    s_lshl_b32 s36, s36, 5
    s_add_u32 s36, s36, 28672
    v_mul_u32_u24 v56, 1040, v6
    v_lshl_add_u32 v56, v5, 6, v56
    v_add_u32 v56, s36, v56
    s_cmp_eq_u32 s75, 0
K2_W0:
    s_setprio 2
    s_waitcnt lgkmcnt(5)
    s_barrier
K2_NOBD:
    s_mov_b64 exec, s[58:59]
    s_cbranch_execnz K2_MORE
K2_MOREB:
    s_cbranch_scc1 K2_W1
    s_mov_b64 exec, -1
    s_lshl_b32 s74, s21, 12
    s_add_u32 s74, s74, 6848512
    buffer_load_dwordx4 v[92:95], v7, s[4:7], s74 offen offset:0
    buffer_load_dwordx4 v[96:99], v7, s[4:7], s74 offen offset:1024
    buffer_load_dwordx4 v[100:103], v7, s[4:7], s74 offen offset:2048
    buffer_load_dwordx4 v[104:107], v7, s[4:7], s74 offen offset:3072
    s_waitcnt vmcnt(4)
    s_branch K2_RECS
K2_W1:
    s_cmp_eq_u32 s56, 0
    s_cbranch_scc1 K2_W2
    s_mov_b64 exec, -1
    v_bfe_u32 v12, v0, 4, 5
    v_xor_b32 v13, v12, v0
    v_and_b32 v13, 15, v13
    s_lshl_b32 s35, s20, 8
    v_lshl_add_u32 v12, v12, 16, s35
    s_and_b32 s37, s21, 7
    s_lshl_b32 s36, s37, 10
    s_add_u32 s36, s36, 115456
    s_mov_b32 m0, s36
    s_mov_b32 s14, 0x271000
    s_mov_b32 s15, 0x20000
    v_lshl_add_u32 v12, v13, 4, v12
    buffer_load_dwordx4 v12, s[12:15], 0 offen lds
    s_add_u32 s36, s36, 8192
    s_mov_b32 m0, s36
    v_add_u32 v12, 0x200000, v12
    s_cmp_lt_u32 s37, 3
    s_cbranch_scc1 K2_X2
    s_waitcnt vmcnt(1)
    s_branch K2_RECS
K2_X2:
    buffer_load_dwordx4 v12, s[12:15], 0 offen lds
    s_waitcnt vmcnt(2)
    s_branch K2_RECS
K2_W2:
    s_waitcnt vmcnt(0)
K2_RECS:
    s_mov_b64 exec, s[40:41]
    v_lshrrev_b32 v19, 24, v62
    ds_add_rtn_u32 v63, v19, v59 offset:768
    v_and_b32 v62, 0x3ffffff, v62
    s_mov_b64 exec, s[42:43]
    v_lshrrev_b32 v20, 24, v66
    ds_add_rtn_u32 v67, v20, v59 offset:768
    v_and_b32 v66, 0x3ffffff, v66
    s_mov_b64 exec, s[44:45]
    s_cbranch_execz K2_HISTD
    v_lshrrev_b32 v21, 24, v70
    ds_add_rtn_u32 v71, v21, v59 offset:768
    v_and_b32 v70, 0x3ffffff, v70
    s_mov_b64 exec, s[46:47]
    s_cbranch_execz K2_HISTD
    v_lshrrev_b32 v22, 24, v74
    ds_add_rtn_u32 v75, v22, v59 offset:768
    v_and_b32 v74, 0x3ffffff, v74
    s_mov_b64 exec, s[48:49]
    s_cbranch_execz K2_HISTD
    v_lshrrev_b32 v23, 24, v78
    ds_add_rtn_u32 v79, v23, v59 offset:768
    v_and_b32 v78, 0x3ffffff, v78
    s_mov_b64 exec, s[50:51]
    s_cbranch_execz K2_HISTD
    v_lshrrev_b32 v24, 24, v82
    ds_add_rtn_u32 v83, v24, v59 offset:768
    v_and_b32 v82, 0x3ffffff, v82
K2_HISTD:
    s_mov_b64 exec, -1
    s_cmp_lg_u32 s76, 0
    s_cbranch_scc1 K2_NOW3
    s_lshl_b32 s34, s23, 10
    s_add_u32 s35, s34, 26624
    s_add_u32 s34, s34, 6979584
    s_mov_b32 m0, s35
    s_nop 0
    buffer_load_dwordx4 v7, s[4:7], s34 offen lds
K2_NOW3:
    s_waitcnt lgkmcnt(0)
    s_barrier
    ds_read_b32 v120, v58 offset:768
    s_waitcnt lgkmcnt(0)
    v_add_u32 v121, 12, v120
    v_and_b32 v121, -16, v121
    v_max_u32 v121, v123, v121
    s_nop 1
    v_add_u32_dpp v122, v121, v121 row_shr:1 row_mask:0xf bank_mask:0xf bound_ctrl:1
    s_nop 1
    v_add_u32_dpp v122, v122, v122 row_shr:2 row_mask:0xf bank_mask:0xf
    s_nop 1
    v_add_u32_dpp v122, v122, v122 row_shr:4 row_mask:0xf bank_mask:0xf
    s_nop 1
    v_add_u32_dpp v122, v122, v122 row_shr:8 row_mask:0xf bank_mask:0xf
    s_nop 1
    v_add_u32_dpp v122, v122, v122 row_bcast:15 row_mask:0xa bank_mask:0xf
    s_nop 1
    v_add_u32_dpp v122, v122, v122 row_bcast:31 row_mask:0xc bank_mask:0xf
    v_sub_u32 v123, v122, v121
    v_readlane_b32 s34, v122, 63
    ds_bpermute_b32 v19, v19, v123
    ds_bpermute_b32 v20, v20, v123
    ds_bpermute_b32 v21, v21, v123
    s_cmp_eq_u64 s[46:47], 0
    s_cbranch_scc1 K2_BPD
    ds_bpermute_b32 v22, v22, v123
    s_cmp_eq_u64 s[48:49], 0
    s_cbranch_scc1 K2_BPD
    ds_bpermute_b32 v23, v23, v123
    s_cmp_eq_u64 s[50:51], 0
    s_cbranch_scc1 K2_BPD
    ds_bpermute_b32 v24, v24, v123
K2_BPD:
    s_cmp_gt_u32 s34, 8064
    s_cbranch_scc1 K2_REDO
    s_add_u32 s34, s34, 48
    s_lshr_b32 s35, s34, 9
    s_bfe_u32 s34, s34, 0x30006
    s_mul_i32 s37, s76, s35
    s_waitcnt lgkmcnt(0)
    s_mov_b64 exec, s[40:41]
    v_add_u32 v19, v19, v63
    ds_write_b32 v19, v62 offset:2048
    v_add_u32 v63, v19, v19
    s_mov_b64 exec, s[42:43]
    v_add_u32 v20, v20, v67
    ds_write_b32 v20, v66 offset:2048
    v_add_u32 v67, v20, v20
    s_mov_b64 exec, s[44:45]
    s_cbranch_execz K2_GEO
    v_add_u32 v21, v21, v71
    ds_write_b32 v21, v70 offset:2048
    v_add_u32 v71, v21, v21
    s_mov_b64 exec, s[46:47]
    s_cbranch_execz K2_GEO
    v_add_u32 v22, v22, v75
    ds_write_b32 v22, v74 offset:2048
    v_add_u32 v75, v22, v22
    s_mov_b64 exec, s[48:49]
    s_cbranch_execz K2_GEO
    v_add_u32 v23, v23, v79
    ds_write_b32 v23, v78 offset:2048
    v_add_u32 v79, v23, v23
    s_mov_b64 exec, s[50:51]
    s_cbranch_execz K2_GEO
    v_add_u32 v24, v24, v83
    ds_write_b32 v24, v82 offset:2048
    v_add_u32 v83, v24, v24
K2_GEO:
    s_cmp_lg_u32 s21, 0
    s_cbranch_scc1 K2_NOFL
    s_mov_b64 exec, s[78:79]
    v_lshrrev_b32 v16, 4, v122
    ds_write_b8 v16, v59 offset:1087
K2_NOFL:
    s_min_u32 s38, s76, s34
    s_add_u32 s37, s37, s38
    s_lshl_b32 s60, s37, 6
    s_cmp_lt_u32 s76, s34
    s_addc_u32 s35, s35, 0
    s_mov_b64 exec, -1
    v_and_b32 v86, 32, v1
    v_mul_u32_u24 v86, s35, v86
    s_lshl_b32 s77, s35, 4
    v_add_u32 v86, s60, v86
    v_add_u32 v87, s77, v86
    s_waitcnt vmcnt(0)
K2_NOVM:
    s_cmp_lg_u32 s75, 0
    s_waitcnt lgkmcnt(0)
K2_B2:
    s_barrier
    s_cbranch_scc0 K2_FG
    s_setprio 1
    ds_read_b128 v[8:11], v108 offset:0
    ds_read_b128 v[24:27], v108 offset:4096
    ds_read_b128 v[40:43], v108 offset:8192
    ds_read_b128 v[12:15], v109 offset:0
    ds_read_b128 v[28:31], v109 offset:4096
    ds_read_b128 v[44:47], v109 offset:8192
    ds_read_b128 v[16:19], v110 offset:0
    ds_read_b128 v[32:35], v110 offset:4096
    ds_read_b128 v[48:51], v110 offset:8192
    ds_read_b128 v[20:23], v111 offset:0
    ds_read_b128 v[36:39], v111 offset:4096
    ds_read_b128 v[52:55], v111 offset:8192
    s_waitcnt lgkmcnt(11)
    v_mfma_f32_16x16x32_bf16 v[108:111], v[92:95], v[8:11], 0
    s_waitcnt lgkmcnt(10)
    v_mfma_f32_16x16x32_bf16 v[112:115], v[92:95], v[24:27], 0
    s_waitcnt lgkmcnt(9)
    v_mfma_f32_16x16x32_bf16 v[116:119], v[92:95], v[40:43], 0
    s_waitcnt lgkmcnt(8)
    v_mfma_f32_16x16x32_bf16 v[108:111], v[96:99], v[12:15], v[108:111]
    s_waitcnt lgkmcnt(7)
    v_mfma_f32_16x16x32_bf16 v[112:115], v[96:99], v[28:31], v[112:115]
    s_waitcnt lgkmcnt(6)
    v_mfma_f32_16x16x32_bf16 v[116:119], v[96:99], v[44:47], v[116:119]
    s_waitcnt lgkmcnt(5)
    v_mfma_f32_16x16x32_bf16 v[108:111], v[100:103], v[16:19], v[108:111]
    s_waitcnt lgkmcnt(4)
    v_mfma_f32_16x16x32_bf16 v[112:115], v[100:103], v[32:35], v[112:115]
    s_waitcnt lgkmcnt(3)
    v_mfma_f32_16x16x32_bf16 v[116:119], v[100:103], v[48:51], v[116:119]
    s_waitcnt lgkmcnt(2)
    v_mfma_f32_16x16x32_bf16 v[108:111], v[104:107], v[20:23], v[108:111]
    s_waitcnt lgkmcnt(1)
    v_mfma_f32_16x16x32_bf16 v[112:115], v[104:107], v[36:39], v[112:115]
    s_waitcnt lgkmcnt(0)
    v_mfma_f32_16x16x32_bf16 v[116:119], v[104:107], v[52:55], v[116:119]
    s_mov_b64 exec, s[40:41]
    ds_write_b64 v63, v[60:61] offset:10240
    s_mov_b64 exec, s[42:43]
    ds_write_b64 v67, v[64:65] offset:10240
    s_mov_b64 exec, s[44:45]
    s_cbranch_execz K2_EAQ
    ds_write_b64 v71, v[68:69] offset:10240
    s_mov_b64 exec, s[46:47]
    s_cbranch_execz K2_EAQ
    ds_write_b64 v75, v[72:73] offset:10240
    s_mov_b64 exec, s[48:49]
    s_cbranch_execz K2_EAQ
    ds_write_b64 v79, v[76:77] offset:10240
    s_mov_b64 exec, s[50:51]
    s_cbranch_execz K2_EAQ
    ds_write_b64 v83, v[80:81] offset:10240
K2_EAQ:
    s_mov_b64 exec, -1
    s_nop 0
    v_pk_mul_f32 v[108:109], v[108:109], s[72:73] op_sel_hi:[1,0]
    v_pk_mul_f32 v[110:111], v[110:111], s[72:73] op_sel_hi:[1,0]
    ds_write_b64 v56, v[108:109] offset:0
    ds_write_b64 v56, v[110:111] offset:16
    v_pk_mul_f32 v[112:113], v[112:113], s[72:73] op_sel_hi:[1,0]
    v_pk_mul_f32 v[114:115], v[114:115], s[72:73] op_sel_hi:[1,0]
    ds_write_b64 v56, v[112:113] offset:16640
    ds_write_b64 v56, v[114:115] offset:16656
    s_mov_b32 exec_lo, 0x01ff01ff
    s_mov_b32 exec_hi, 0x01ff01ff
    v_pk_mul_f32 v[116:117], v[116:117], s[72:73] op_sel_hi:[1,0]
    v_pk_mul_f32 v[118:119], v[118:119], s[72:73] op_sel_hi:[1,0]
    ds_write_b64 v56, v[116:117] offset:33280
    ds_write_b64 v56, v[118:119] offset:33296
    s_mov_b64 exec, -1
    s_waitcnt lgkmcnt(0)
    s_barrier
    v_exp_f32 v92, v108
    v_exp_f32 v93, v109
    v_exp_f32 v94, v110
    v_exp_f32 v95, v111
    v_exp_f32 v96, v112
    v_exp_f32 v97, v113
    v_exp_f32 v98, v114
    v_exp_f32 v99, v115
    v_exp_f32 v100, v116
    v_exp_f32 v101, v117
    v_exp_f32 v102, v118
    v_exp_f32 v103, v119
    v_pk_fma_f32 v[92:93], v[92:93], s[26:27], s[26:27] op_sel_hi:[1,0,0] clamp
    v_pk_fma_f32 v[94:95], v[94:95], s[26:27], s[26:27] op_sel_hi:[1,0,0] clamp
    v_pk_fma_f32 v[96:97], v[96:97], s[26:27], s[26:27] op_sel_hi:[1,0,0] clamp
    v_pk_fma_f32 v[98:99], v[98:99], s[26:27], s[26:27] op_sel_hi:[1,0,0] clamp
    v_pk_fma_f32 v[100:101], v[100:101], s[26:27], s[26:27] op_sel_hi:[1,0,0] clamp
    v_pk_fma_f32 v[102:103], v[102:103], s[26:27], s[26:27] op_sel_hi:[1,0,0] clamp
    v_rcp_f32 v92, v92
    v_rcp_f32 v93, v93
    v_rcp_f32 v94, v94
    v_rcp_f32 v95, v95
    v_rcp_f32 v96, v96
    v_rcp_f32 v97, v97
    v_rcp_f32 v98, v98
    v_rcp_f32 v99, v99
    v_rcp_f32 v100, v100
    v_rcp_f32 v101, v101
    v_rcp_f32 v102, v102
    v_rcp_f32 v103, v103
    v_pk_mul_f32 v[92:93], v[92:93], v[108:109]
    v_pk_mul_f32 v[94:95], v[94:95], v[110:111]
    ds_write_b64 v56, v[92:93] offset:8
    ds_write_b64 v56, v[94:95] offset:24
    v_pk_mul_f32 v[96:97], v[96:97], v[112:113]
    v_pk_mul_f32 v[98:99], v[98:99], v[114:115]
    ds_write_b64 v56, v[96:97] offset:16648
    ds_write_b64 v56, v[98:99] offset:16664
    s_mov_b32 exec_lo, 0x01ff01ff
    s_mov_b32 exec_hi, 0x01ff01ff
    v_pk_mul_f32 v[100:101], v[100:101], v[116:117]
    v_pk_mul_f32 v[102:103], v[102:103], v[118:119]
    ds_write_b64 v56, v[100:101] offset:33288
    ds_write_b64 v56, v[102:103] offset:33304
    s_mov_b64 exec, -1
    s_setprio 0
    ds_read_b128 v[8:11], v86 offset:2048
    ds_read_b128 v[12:15], v87 offset:2048
    ds_read_b128 v[48:51], v86 offset:2064
    ds_read_b128 v[52:55], v87 offset:2064
    s_waitcnt lgkmcnt(2)
    buffer_load_dword v24, v8, s[8:11], 0 offen
    buffer_load_dword v25, v12, s[8:11], 0 offen
    buffer_load_dword v26, v9, s[8:11], 0 offen
    buffer_load_dword v27, v13, s[8:11], 0 offen
    buffer_load_dword v28, v10, s[8:11], 0 offen
    buffer_load_dword v29, v14, s[8:11], 0 offen
    buffer_load_dword v30, v11, s[8:11], 0 offen
    buffer_load_dword v31, v15, s[8:11], 0 offen
    s_waitcnt lgkmcnt(0)
    buffer_load_dword v16, v48, s[8:11], 0 offen
    buffer_load_dword v17, v52, s[8:11], 0 offen
    buffer_load_dword v18, v49, s[8:11], 0 offen
    buffer_load_dword v19, v53, s[8:11], 0 offen
    buffer_load_dword v20, v50, s[8:11], 0 offen
    buffer_load_dword v21, v54, s[8:11], 0 offen
    buffer_load_dword v22, v51, s[8:11], 0 offen
    buffer_load_dword v23, v55, s[8:11], 0 offen
    s_setprio 3
    v_lshrrev_b32 v8, 4, v86
    v_add_u32 v8, v8, v91
    v_add_u32 v9, s35, v8
    ds_read_u8 v8, v8 offset:1088
    ds_read_u8 v9, v9 offset:1088
    ds_read_b128 v[68:71], v125 offset:26624
    s_add_u32 s61, s60, s77
    s_add_u32 s62, s61, s77
    s_add_u32 s63, s62, s77
    s_mov_b64 exec, s[78:79]
    v_cmp_ge_u32 vcc, s60, v122
    s_bcnt1_i32_b64 s64, vcc
    v_cmp_ge_u32 vcc, s61, v122
    s_bcnt1_i32_b64 s65, vcc
    v_cmp_ge_u32 vcc, s62, v122
    s_bcnt1_i32_b64 s66, vcc
    v_cmp_ge_u32 vcc, s63, v122
    s_bcnt1_i32_b64 s67, vcc
    v_sub_u32 v121, v121, v120
    v_add_u32 v126, v126, v121
    s_mov_b32 exec_hi, 0
    v_mad_u32_u24 v91, s65, v124, v90
    v_mad_u32_u24 v90, s64, v124, v90
    s_not_b64 exec, exec
    v_mad_u32_u24 v91, s67, v124, v90
    v_mad_u32_u24 v90, s66, v124, v90
    s_mov_b64 exec, -1
    s_lshl_b32 s36, s35, 5
    s_lshl1_add_u32 s37, s60, 10240
    v_mad_u32_u24 v88, v57, s36, v88
    v_mad_u32_u24 v88, v89, s37, v88
    v_mov_b64 v[80:81], 0
    v_mov_b64 v[82:83], 0
    v_mov_b64 v[120:121], 0
    v_mov_b64 v[76:77], s[52:53]
    v_mov_b64 v[78:79], s[52:53]
    s_sub_u32 s34, 16, s35
    s_add_u32 s38, s77, 1792
    s_sub_u32 s39, s36, 512
    s_waitcnt lgkmcnt(0)
    v_cmp_ne_u32 s[28:29], 0, v8
    v_cmp_ne_u32 s[30:31], 0, v9
    s_branch K2_NOB
K2_FG:
    ds_read_b128 v[8:11], v86 offset:2048
    ds_read_b128 v[12:15], v87 offset:2048
    ds_read_b128 v[48:51], v86 offset:2064
    ds_read_b128 v[52:55], v87 offset:2064
    s_waitcnt lgkmcnt(2)
    buffer_load_dword v24, v8, s[8:11], 0 offen
    buffer_load_dword v25, v12, s[8:11], 0 offen
    buffer_load_dword v26, v9, s[8:11], 0 offen
    buffer_load_dword v27, v13, s[8:11], 0 offen
    buffer_load_dword v28, v10, s[8:11], 0 offen
    buffer_load_dword v29, v14, s[8:11], 0 offen
    buffer_load_dword v30, v11, s[8:11], 0 offen
    buffer_load_dword v31, v15, s[8:11], 0 offen
    s_waitcnt lgkmcnt(0)
    buffer_load_dword v16, v48, s[8:11], 0 offen
    buffer_load_dword v17, v52, s[8:11], 0 offen
    buffer_load_dword v18, v49, s[8:11], 0 offen
    buffer_load_dword v19, v53, s[8:11], 0 offen
    buffer_load_dword v20, v50, s[8:11], 0 offen
    buffer_load_dword v21, v54, s[8:11], 0 offen
    buffer_load_dword v22, v51, s[8:11], 0 offen
    buffer_load_dword v23, v55, s[8:11], 0 offen
    s_mov_b64 exec, s[40:41]
    ds_write_b64 v63, v[60:61] offset:10240
    s_mov_b64 exec, s[42:43]
    ds_write_b64 v67, v[64:65] offset:10240
    s_mov_b64 exec, s[44:45]
    s_cbranch_execz K2_EAR
    ds_write_b64 v71, v[68:69] offset:10240
    s_mov_b64 exec, s[46:47]
    s_cbranch_execz K2_EAR
    ds_write_b64 v75, v[72:73] offset:10240
    s_mov_b64 exec, s[48:49]
    s_cbranch_execz K2_EAR
    ds_write_b64 v79, v[76:77] offset:10240
    s_mov_b64 exec, s[50:51]
    s_cbranch_execz K2_EAR
    ds_write_b64 v83, v[80:81] offset:10240
K2_EAR:
    s_mov_b64 exec, -1
    v_lshrrev_b32 v8, 4, v86
    v_add_u32 v8, v8, v91
    v_add_u32 v9, s35, v8
    ds_read_u8 v8, v8 offset:1088
    ds_read_u8 v9, v9 offset:1088
    ds_read_b128 v[68:71], v125 offset:26624
    s_add_u32 s61, s60, s77
    s_add_u32 s62, s61, s77
    s_add_u32 s63, s62, s77
    s_mov_b64 exec, s[78:79]
    v_cmp_ge_u32 vcc, s60, v122
    s_bcnt1_i32_b64 s64, vcc
    v_cmp_ge_u32 vcc, s61, v122
    s_bcnt1_i32_b64 s65, vcc
    v_cmp_ge_u32 vcc, s62, v122
    s_bcnt1_i32_b64 s66, vcc
    v_cmp_ge_u32 vcc, s63, v122
    s_bcnt1_i32_b64 s67, vcc
    v_sub_u32 v121, v121, v120
    v_add_u32 v126, v126, v121
    s_mov_b32 exec_hi, 0
    v_mad_u32_u24 v91, s65, v124, v90
    v_mad_u32_u24 v90, s64, v124, v90
    s_not_b64 exec, exec
    v_mad_u32_u24 v91, s67, v124, v90
    v_mad_u32_u24 v90, s66, v124, v90
    s_mov_b64 exec, -1
    s_lshl_b32 s36, s35, 5
    s_lshl1_add_u32 s37, s60, 10240
    v_mad_u32_u24 v88, v57, s36, v88
    v_mad_u32_u24 v88, v89, s37, v88
    v_mov_b64 v[80:81], 0
    v_mov_b64 v[82:83], 0
    v_mov_b64 v[120:121], 0
    v_mov_b64 v[76:77], s[52:53]
    v_mov_b64 v[78:79], s[52:53]
    s_sub_u32 s34, 16, s35
    s_add_u32 s38, s77, 1792
    s_sub_u32 s39, s36, 512
    s_waitcnt lgkmcnt(0)
    v_cmp_ne_u32 s[28:29], 0, v8
    v_cmp_ne_u32 s[30:31], 0, v9
    s_barrier
K2_NOB:
    ds_read_b64 v[72:73], v90
    ds_read_b64 v[74:75], v91
    ds_read2_b64 v[64:67], v88 offset0:0 offset1:0
    ds_read_b128 v[8:11], v86 offset:2080
    ds_read_b128 v[12:15], v87 offset:2080
    s_mov_b32 s56, 0
    s_lshl_b64 s[28:29], s[28:29], s34
    s_or_b32 s36, s28, s29
    s_lshr_b32 s37, s36, 1
    s_or_b32 s32, s36, s37
    s_lshl_b64 s[30:31], s[30:31], s34
    s_or_b32 s36, s30, s31
    s_lshr_b32 s37, s36, 1
    s_or_b32 s33, s36, s37
    s_or_b32 s34, s34, 0x10000
    s_bitcmp1_b32 s35, 0
    s_waitcnt vmcnt(8) lgkmcnt(0)
    s_cbranch_scc1 K2_PA1
    v_mfma_f32_4x4x4_16b_bf16 v[32:35], v[84:85], v[24:25], v[72:75]
    v_mfma_f32_4x4x4_16b_bf16 v[36:39], v[84:85], v[26:27], v[72:75]
    v_mfma_f32_4x4x4_16b_bf16 v[40:43], v[84:85], v[28:29], v[72:75]
    v_mfma_f32_4x4x4_16b_bf16 v[44:47], v[84:85], v[30:31], v[72:75]
    s_nop 3
    v_mfma_f32_32x32x16_bf16 v[32:47], v[64:67], v[68:71], v[32:47]
    s_branch K2_PAD
K2_PA1:
    v_mfma_f32_4x4x4_16b_bf16 v[92:95], v[84:85], v[24:25], v[72:75]
    v_mfma_f32_4x4x4_16b_bf16 v[96:99], v[84:85], v[26:27], v[72:75]
    v_mfma_f32_4x4x4_16b_bf16 v[100:103], v[84:85], v[28:29], v[72:75]
    v_mfma_f32_4x4x4_16b_bf16 v[104:107], v[84:85], v[30:31], v[72:75]
    s_nop 3
    v_mfma_f32_32x32x16_bf16 v[92:107], v[64:67], v[68:71], v[92:107]
K2_PAD:
    ds_read2_b64 v[64:67], v88 offset0:4 offset1:4
    s_bfe_i32 exec_lo, s28, s34
    s_bfe_i32 exec_hi, s29, s34
    ds_read_b64 v[72:73], v90 offset:1040
    s_bfe_i32 exec_lo, s30, s34
    s_bfe_i32 exec_hi, s31, s34
    ds_read_b64 v[74:75], v91 offset:1040
    s_mov_b64 exec, -1
    v_mad_i32_i24 v88, v89, s39, v88
    v_add_u32 v86, s38, v86
    v_add_u32 v87, s38, v87
    s_setprio 2
    s_cmp_lg_u32 s68, 0
    s_cbranch_scc1 K2_GUARDED
    s_cmp_eq_u32 s35, 10
    s_cbranch_scc1 K2_T6
    s_cmp_eq_u32 s35, 11
    s_cbranch_scc1 K2_T5
    s_cmp_eq_u32 s35, 9
    s_cbranch_scc1 K2_T7
    s_cmp_eq_u32 s35, 12
    s_cbranch_scc1 K2_T4
    s_cmp_eq_u32 s35, 8
    s_cbranch_scc1 K2_T8
    s_cmp_eq_u32 s35, 13
    s_cbranch_scc1 K2_T3
    s_cmp_eq_u32 s35, 7
    s_cbranch_scc1 K2_T9
    s_cmp_eq_u32 s35, 14
    s_cbranch_scc1 K2_T2
    s_cmp_eq_u32 s35, 6
    s_cbranch_scc1 K2_T10
    s_cmp_eq_u32 s35, 15
    s_cbranch_scc1 K2_T1
    s_cmp_eq_u32 s35, 5
    s_cbranch_scc1 K2_T11
    s_cmp_eq_u32 s35, 4
    s_cbranch_scc1 K2_T12
    s_cmp_eq_u32 s35, 3
    s_cbranch_scc1 K2_T13
    s_cmp_eq_u32 s35, 2
    s_cbranch_scc1 K2_T14
    s_cmp_eq_u32 s35, 1
    s_cbranch_scc1 K2_T15
K2_LOOP:
K2_T0:
    v_exp_f32 v48, v32
    v_exp_f32 v49, v33
    s_waitcnt vmcnt(0) lgkmcnt(0)
    v_mfma_f32_4x4x4_16b_bf16 v[92:95], v[84:85], v[16:17], v[72:75]
    v_exp_f32 v50, v34
    v_mfma_f32_4x4x4_16b_bf16 v[96:99], v[84:85], v[18:19], v[72:75]
    v_exp_f32 v51, v35
    v_mfma_f32_4x4x4_16b_bf16 v[100:103], v[84:85], v[20:21], v[72:75]
    v_exp_f32 v52, v36
    v_mfma_f32_4x4x4_16b_bf16 v[104:107], v[84:85], v[22:23], v[72:75]
    v_exp_f32 v53, v37
    v_exp_f32 v54, v38
    v_exp_f32 v55, v39
    v_exp_f32 v56, v40
    v_mfma_f32_32x32x16_bf16 v[92:107], v[64:67], v[68:71], v[92:107]
    v_exp_f32 v57, v41
    v_exp_f32 v58, v42
    v_exp_f32 v59, v43
    v_exp_f32 v60, v44
    v_exp_f32 v61, v45
    buffer_load_dword v16, v8, s[8:11], 0 offen
    buffer_load_dword v17, v12, s[8:11], 0 offen
    buffer_load_dword v18, v9, s[8:11], 0 offen
    buffer_load_dword v19, v13, s[8:11], 0 offen
    buffer_load_dword v20, v10, s[8:11], 0 offen
    buffer_load_dword v21, v14, s[8:11], 0 offen
    buffer_load_dword v22, v11, s[8:11], 0 offen
    buffer_load_dword v23, v15, s[8:11], 0 offen
    ds_read_b128 v[8:11], v86 offset:48
    ds_read_b128 v[12:15], v87 offset:48
    ds_read2_b64 v[64:67], v88 offset0:8 offset1:8
    v_exp_f32 v62, v46
    v_exp_f32 v63, v47
    v_pk_fma_f32 v[80:81], v[80:81], v[48:49], v[80:81]
    v_pk_fma_f32 v[82:83], v[82:83], v[50:51], v[82:83]
    v_pk_fma_f32 v[80:81], v[32:33], v[76:77], v[80:81]
    v_pk_fma_f32 v[82:83], v[34:35], v[78:79], v[82:83]
    v_pk_fma_f32 v[76:77], v[76:77], v[48:49], v[76:77]
    v_pk_fma_f32 v[78:79], v[78:79], v[50:51], v[78:79]
    v_pk_fma_f32 v[80:81], v[80:81], v[52:53], v[80:81]
    v_pk_fma_f32 v[82:83], v[82:83], v[54:55], v[82:83]
    v_pk_fma_f32 v[80:81], v[36:37], v[76:77], v[80:81]
    v_pk_fma_f32 v[82:83], v[38:39], v[78:79], v[82:83]
    v_pk_fma_f32 v[76:77], v[76:77], v[52:53], v[76:77]
    v_pk_fma_f32 v[78:79], v[78:79], v[54:55], v[78:79]
    v_pk_fma_f32 v[80:81], v[80:81], v[56:57], v[80:81]
    v_pk_fma_f32 v[82:83], v[82:83], v[58:59], v[82:83]
    v_pk_fma_f32 v[80:81], v[40:41], v[76:77], v[80:81]
    v_pk_fma_f32 v[82:83], v[42:43], v[78:79], v[82:83]
    v_pk_fma_f32 v[76:77], v[76:77], v[56:57], v[76:77]
    v_pk_fma_f32 v[78:79], v[78:79], v[58:59], v[78:79]
    v_pk_fma_f32 v[80:81], v[80:81], v[60:61], v[80:81]
    v_pk_fma_f32 v[82:83], v[82:83], v[62:63], v[82:83]
    v_pk_fma_f32 v[80:81], v[44:45], v[76:77], v[80:81]
    v_pk_fma_f32 v[82:83], v[46:47], v[78:79], v[82:83]
    v_pk_fma_f32 v[76:77], v[76:77], v[60:61], v[76:77]
    v_pk_fma_f32 v[78:79], v[78:79], v[62:63], v[78:79]
    s_bitcmp1_b32 s32, 0
    s_cbranch_scc1 K2_EV0_0
K2_EB0_0:
    s_bitcmp1_b32 s33, 0
    s_cbranch_scc1 K2_EV0_1
K2_EB0_1:
K2_T1:
    v_exp_f32 v48, v92
    v_exp_f32 v49, v93
    s_waitcnt vmcnt(0) lgkmcnt(0)
    v_mfma_f32_4x4x4_16b_bf16 v[32:35], v[84:85], v[16:17], v[72:75]
    v_exp_f32 v50, v94
    v_mfma_f32_4x4x4_16b_bf16 v[36:39], v[84:85], v[18:19], v[72:75]
    v_exp_f32 v51, v95
    v_mfma_f32_4x4x4_16b_bf16 v[40:43], v[84:85], v[20:21], v[72:75]
    v_exp_f32 v52, v96
    v_mfma_f32_4x4x4_16b_bf16 v[44:47], v[84:85], v[22:23], v[72:75]
    v_exp_f32 v53, v97
    v_exp_f32 v54, v98
    v_exp_f32 v55, v99
    v_exp_f32 v56, v100
    v_mfma_f32_32x32x16_bf16 v[32:47], v[64:67], v[68:71], v[32:47]
    v_exp_f32 v57, v101
    v_exp_f32 v58, v102
    v_exp_f32 v59, v103
    v_exp_f32 v60, v104
    v_exp_f32 v61, v105
    buffer_load_dword v16, v8, s[8:11], 0 offen
    buffer_load_dword v17, v12, s[8:11], 0 offen
    buffer_load_dword v18, v9, s[8:11], 0 offen
    buffer_load_dword v19, v13, s[8:11], 0 offen
    buffer_load_dword v20, v10, s[8:11], 0 offen
    buffer_load_dword v21, v14, s[8:11], 0 offen
    buffer_load_dword v22, v11, s[8:11], 0 offen
    buffer_load_dword v23, v15, s[8:11], 0 offen
    ds_read_b128 v[8:11], v86 offset:64
    ds_read_b128 v[12:15], v87 offset:64
    ds_read2_b64 v[64:67], v88 offset0:12 offset1:12
    v_exp_f32 v62, v106
    v_exp_f32 v63, v107
    v_pk_fma_f32 v[80:81], v[80:81], v[48:49], v[80:81]
    v_pk_fma_f32 v[82:83], v[82:83], v[50:51], v[82:83]
    v_pk_fma_f32 v[80:81], v[92:93], v[76:77], v[80:81]
    v_pk_fma_f32 v[82:83], v[94:95], v[78:79], v[82:83]
    v_pk_fma_f32 v[76:77], v[76:77], v[48:49], v[76:77]
    v_pk_fma_f32 v[78:79], v[78:79], v[50:51], v[78:79]
    v_pk_fma_f32 v[80:81], v[80:81], v[52:53], v[80:81]
    v_pk_fma_f32 v[82:83], v[82:83], v[54:55], v[82:83]
    v_pk_fma_f32 v[80:81], v[96:97], v[76:77], v[80:81]
    v_pk_fma_f32 v[82:83], v[98:99], v[78:79], v[82:83]
    v_pk_fma_f32 v[76:77], v[76:77], v[52:53], v[76:77]
    v_pk_fma_f32 v[78:79], v[78:79], v[54:55], v[78:79]
    v_pk_fma_f32 v[80:81], v[80:81], v[56:57], v[80:81]
    v_pk_fma_f32 v[82:83], v[82:83], v[58:59], v[82:83]
    v_pk_fma_f32 v[80:81], v[100:101], v[76:77], v[80:81]
    v_pk_fma_f32 v[82:83], v[102:103], v[78:79], v[82:83]
    v_pk_fma_f32 v[76:77], v[76:77], v[56:57], v[76:77]
    v_pk_fma_f32 v[78:79], v[78:79], v[58:59], v[78:79]
    v_pk_fma_f32 v[80:81], v[80:81], v[60:61], v[80:81]
    v_pk_fma_f32 v[82:83], v[82:83], v[62:63], v[82:83]
    v_pk_fma_f32 v[80:81], v[104:105], v[76:77], v[80:81]
    v_pk_fma_f32 v[82:83], v[106:107], v[78:79], v[82:83]
    v_pk_fma_f32 v[76:77], v[76:77], v[60:61], v[76:77]
    v_pk_fma_f32 v[78:79], v[78:79], v[62:63], v[78:79]
    s_bitcmp1_b32 s32, 1
    s_cbranch_scc1 K2_EV1_0
K2_EB1_0:
    s_bitcmp1_b32 s33, 1
    s_cbranch_scc1 K2_EV1_1
K2_EB1_1:
K2_T2:
    v_exp_f32 v48, v32
    v_exp_f32 v49, v33
    s_waitcnt vmcnt(0) lgkmcnt(0)
    v_mfma_f32_4x4x4_16b_bf16 v[92:95], v[84:85], v[16:17], v[72:75]
    v_exp_f32 v50, v34
    v_mfma_f32_4x4x4_16b_bf16 v[96:99], v[84:85], v[18:19], v[72:75]
    v_exp_f32 v51, v35
    v_mfma_f32_4x4x4_16b_bf16 v[100:103], v[84:85], v[20:21], v[72:75]
    v_exp_f32 v52, v36
    v_mfma_f32_4x4x4_16b_bf16 v[104:107], v[84:85], v[22:23], v[72:75]
    v_exp_f32 v53, v37
    v_exp_f32 v54, v38
    v_exp_f32 v55, v39
    v_exp_f32 v56, v40
    v_mfma_f32_32x32x16_bf16 v[92:107], v[64:67], v[68:71], v[92:107]
    v_exp_f32 v57, v41
    v_exp_f32 v58, v42
    v_exp_f32 v59, v43
    v_exp_f32 v60, v44
    v_exp_f32 v61, v45
    buffer_load_dword v16, v8, s[8:11], 0 offen
    buffer_load_dword v17, v12, s[8:11], 0 offen
    buffer_load_dword v18, v9, s[8:11], 0 offen
    buffer_load_dword v19, v13, s[8:11], 0 offen
    buffer_load_dword v20, v10, s[8:11], 0 offen
    buffer_load_dword v21, v14, s[8:11], 0 offen
    buffer_load_dword v22, v11, s[8:11], 0 offen
    buffer_load_dword v23, v15, s[8:11], 0 offen
    ds_read_b128 v[8:11], v86 offset:80
    ds_read_b128 v[12:15], v87 offset:80
    ds_read2_b64 v[64:67], v88 offset0:16 offset1:16
    v_exp_f32 v62, v46
    v_exp_f32 v63, v47
    v_pk_fma_f32 v[80:81], v[80:81], v[48:49], v[80:81]
    v_pk_fma_f32 v[82:83], v[82:83], v[50:51], v[82:83]
    v_pk_fma_f32 v[80:81], v[32:33], v[76:77], v[80:81]
    v_pk_fma_f32 v[82:83], v[34:35], v[78:79], v[82:83]
    v_pk_fma_f32 v[76:77], v[76:77], v[48:49], v[76:77]
    v_pk_fma_f32 v[78:79], v[78:79], v[50:51], v[78:79]
    v_pk_fma_f32 v[80:81], v[80:81], v[52:53], v[80:81]
    v_pk_fma_f32 v[82:83], v[82:83], v[54:55], v[82:83]
    v_pk_fma_f32 v[80:81], v[36:37], v[76:77], v[80:81]
    v_pk_fma_f32 v[82:83], v[38:39], v[78:79], v[82:83]
    v_pk_fma_f32 v[76:77], v[76:77], v[52:53], v[76:77]
    v_pk_fma_f32 v[78:79], v[78:79], v[54:55], v[78:79]
    v_pk_fma_f32 v[80:81], v[80:81], v[56:57], v[80:81]
    v_pk_fma_f32 v[82:83], v[82:83], v[58:59], v[82:83]
    v_pk_fma_f32 v[80:81], v[40:41], v[76:77], v[80:81]
    v_pk_fma_f32 v[82:83], v[42:43], v[78:79], v[82:83]
    v_pk_fma_f32 v[76:77], v[76:77], v[56:57], v[76:77]
    v_pk_fma_f32 v[78:79], v[78:79], v[58:59], v[78:79]
    v_pk_fma_f32 v[80:81], v[80:81], v[60:61], v[80:81]
    v_pk_fma_f32 v[82:83], v[82:83], v[62:63], v[82:83]
    v_pk_fma_f32 v[80:81], v[44:45], v[76:77], v[80:81]
    v_pk_fma_f32 v[82:83], v[46:47], v[78:79], v[82:83]
    v_pk_fma_f32 v[76:77], v[76:77], v[60:61], v[76:77]
    v_pk_fma_f32 v[78:79], v[78:79], v[62:63], v[78:79]
    s_bitcmp1_b32 s32, 2
    s_cbranch_scc1 K2_EV2_0
K2_EB2_0:
    s_bitcmp1_b32 s33, 2
    s_cbranch_scc1 K2_EV2_1
K2_EB2_1:
K2_T3:
    v_exp_f32 v48, v92
    v_exp_f32 v49, v93
    s_waitcnt vmcnt(0) lgkmcnt(0)
    v_mfma_f32_4x4x4_16b_bf16 v[32:35], v[84:85], v[16:17], v[72:75]
    v_exp_f32 v50, v94
    v_mfma_f32_4x4x4_16b_bf16 v[36:39], v[84:85], v[18:19], v[72:75]
    v_exp_f32 v51, v95
    v_mfma_f32_4x4x4_16b_bf16 v[40:43], v[84:85], v[20:21], v[72:75]
    v_exp_f32 v52, v96
    v_mfma_f32_4x4x4_16b_bf16 v[44:47], v[84:85], v[22:23], v[72:75]
    v_exp_f32 v53, v97
    v_exp_f32 v54, v98
    v_exp_f32 v55, v99
    v_exp_f32 v56, v100
    v_mfma_f32_32x32x16_bf16 v[32:47], v[64:67], v[68:71], v[32:47]
    v_exp_f32 v57, v101
    v_exp_f32 v58, v102
    v_exp_f32 v59, v103
    v_exp_f32 v60, v104
    v_exp_f32 v61, v105
    buffer_load_dword v16, v8, s[8:11], 0 offen
    buffer_load_dword v17, v12, s[8:11], 0 offen
    buffer_load_dword v18, v9, s[8:11], 0 offen
    buffer_load_dword v19, v13, s[8:11], 0 offen
    buffer_load_dword v20, v10, s[8:11], 0 offen
    buffer_load_dword v21, v14, s[8:11], 0 offen
    buffer_load_dword v22, v11, s[8:11], 0 offen
    buffer_load_dword v23, v15, s[8:11], 0 offen
    ds_read_b128 v[8:11], v86 offset:96
    ds_read_b128 v[12:15], v87 offset:96
    ds_read2_b64 v[64:67], v88 offset0:20 offset1:20
    v_exp_f32 v62, v106
    v_exp_f32 v63, v107
    v_pk_fma_f32 v[80:81], v[80:81], v[48:49], v[80:81]
    v_pk_fma_f32 v[82:83], v[82:83], v[50:51], v[82:83]
    v_pk_fma_f32 v[80:81], v[92:93], v[76:77], v[80:81]
    v_pk_fma_f32 v[82:83], v[94:95], v[78:79], v[82:83]
    v_pk_fma_f32 v[76:77], v[76:77], v[48:49], v[76:77]
    v_pk_fma_f32 v[78:79], v[78:79], v[50:51], v[78:79]
    v_pk_fma_f32 v[80:81], v[80:81], v[52:53], v[80:81]
    v_pk_fma_f32 v[82:83], v[82:83], v[54:55], v[82:83]
    v_pk_fma_f32 v[80:81], v[96:97], v[76:77], v[80:81]
    v_pk_fma_f32 v[82:83], v[98:99], v[78:79], v[82:83]
    v_pk_fma_f32 v[76:77], v[76:77], v[52:53], v[76:77]
    v_pk_fma_f32 v[78:79], v[78:79], v[54:55], v[78:79]
    v_pk_fma_f32 v[80:81], v[80:81], v[56:57], v[80:81]
    v_pk_fma_f32 v[82:83], v[82:83], v[58:59], v[82:83]
    v_pk_fma_f32 v[80:81], v[100:101], v[76:77], v[80:81]
    v_pk_fma_f32 v[82:83], v[102:103], v[78:79], v[82:83]
    v_pk_fma_f32 v[76:77], v[76:77], v[56:57], v[76:77]
    v_pk_fma_f32 v[78:79], v[78:79], v[58:59], v[78:79]
    v_pk_fma_f32 v[80:81], v[80:81], v[60:61], v[80:81]
    v_pk_fma_f32 v[82:83], v[82:83], v[62:63], v[82:83]
    v_pk_fma_f32 v[80:81], v[104:105], v[76:77], v[80:81]
    v_pk_fma_f32 v[82:83], v[106:107], v[78:79], v[82:83]
    v_pk_fma_f32 v[76:77], v[76:77], v[60:61], v[76:77]
    v_pk_fma_f32 v[78:79], v[78:79], v[62:63], v[78:79]
    s_bitcmp1_b32 s32, 3
    s_cbranch_scc1 K2_EV3_0
K2_EB3_0:
    s_bitcmp1_b32 s33, 3
    s_cbranch_scc1 K2_EV3_1
K2_EB3_1:
K2_T4:
    v_exp_f32 v48, v32
    v_exp_f32 v49, v33
    s_waitcnt vmcnt(0) lgkmcnt(0)
    v_mfma_f32_4x4x4_16b_bf16 v[92:95], v[84:85], v[16:17], v[72:75]
    v_exp_f32 v50, v34
    v_mfma_f32_4x4x4_16b_bf16 v[96:99], v[84:85], v[18:19], v[72:75]
    v_exp_f32 v51, v35
    v_mfma_f32_4x4x4_16b_bf16 v[100:103], v[84:85], v[20:21], v[72:75]
    v_exp_f32 v52, v36
    v_mfma_f32_4x4x4_16b_bf16 v[104:107], v[84:85], v[22:23], v[72:75]
    v_exp_f32 v53, v37
    v_exp_f32 v54, v38
    v_exp_f32 v55, v39
    v_exp_f32 v56, v40
    v_mfma_f32_32x32x16_bf16 v[92:107], v[64:67], v[68:71], v[92:107]
    v_exp_f32 v57, v41
    v_exp_f32 v58, v42
    v_exp_f32 v59, v43
    v_exp_f32 v60, v44
    v_exp_f32 v61, v45
    buffer_load_dword v16, v8, s[8:11], 0 offen
    buffer_load_dword v17, v12, s[8:11], 0 offen
    buffer_load_dword v18, v9, s[8:11], 0 offen
    buffer_load_dword v19, v13, s[8:11], 0 offen
    buffer_load_dword v20, v10, s[8:11], 0 offen
    buffer_load_dword v21, v14, s[8:11], 0 offen
    buffer_load_dword v22, v11, s[8:11], 0 offen
    buffer_load_dword v23, v15, s[8:11], 0 offen
    ds_read_b128 v[8:11], v86 offset:112
    ds_read_b128 v[12:15], v87 offset:112
    ds_read2_b64 v[64:67], v88 offset0:24 offset1:24
    v_exp_f32 v62, v46
    v_exp_f32 v63, v47
    v_pk_fma_f32 v[80:81], v[80:81], v[48:49], v[80:81]
    v_pk_fma_f32 v[82:83], v[82:83], v[50:51], v[82:83]
    v_pk_fma_f32 v[80:81], v[32:33], v[76:77], v[80:81]
    v_pk_fma_f32 v[82:83], v[34:35], v[78:79], v[82:83]
    v_pk_fma_f32 v[76:77], v[76:77], v[48:49], v[76:77]
    v_pk_fma_f32 v[78:79], v[78:79], v[50:51], v[78:79]
    v_pk_fma_f32 v[80:81], v[80:81], v[52:53], v[80:81]
    v_pk_fma_f32 v[82:83], v[82:83], v[54:55], v[82:83]
    v_pk_fma_f32 v[80:81], v[36:37], v[76:77], v[80:81]
    v_pk_fma_f32 v[82:83], v[38:39], v[78:79], v[82:83]
    v_pk_fma_f32 v[76:77], v[76:77], v[52:53], v[76:77]
    v_pk_fma_f32 v[78:79], v[78:79], v[54:55], v[78:79]
    v_pk_fma_f32 v[80:81], v[80:81], v[56:57], v[80:81]
    v_pk_fma_f32 v[82:83], v[82:83], v[58:59], v[82:83]
    v_pk_fma_f32 v[80:81], v[40:41], v[76:77], v[80:81]
    v_pk_fma_f32 v[82:83], v[42:43], v[78:79], v[82:83]
    v_pk_fma_f32 v[76:77], v[76:77], v[56:57], v[76:77]
    v_pk_fma_f32 v[78:79], v[78:79], v[58:59], v[78:79]
    v_pk_fma_f32 v[80:81], v[80:81], v[60:61], v[80:81]
    v_pk_fma_f32 v[82:83], v[82:83], v[62:63], v[82:83]
    v_pk_fma_f32 v[80:81], v[44:45], v[76:77], v[80:81]
    v_pk_fma_f32 v[82:83], v[46:47], v[78:79], v[82:83]
    v_pk_fma_f32 v[76:77], v[76:77], v[60:61], v[76:77]
    v_pk_fma_f32 v[78:79], v[78:79], v[62:63], v[78:79]
    s_bitcmp1_b32 s32, 4
    s_cbranch_scc1 K2_EV4_0
K2_EB4_0:
    s_bitcmp1_b32 s33, 4
    s_cbranch_scc1 K2_EV4_1
K2_EB4_1:
K2_T5:
    v_exp_f32 v48, v92
    v_exp_f32 v49, v93
    s_waitcnt vmcnt(0) lgkmcnt(0)
    v_mfma_f32_4x4x4_16b_bf16 v[32:35], v[84:85], v[16:17], v[72:75]
    v_exp_f32 v50, v94
    v_mfma_f32_4x4x4_16b_bf16 v[36:39], v[84:85], v[18:19], v[72:75]
    v_exp_f32 v51, v95
    v_mfma_f32_4x4x4_16b_bf16 v[40:43], v[84:85], v[20:21], v[72:75]
    v_exp_f32 v52, v96
    v_mfma_f32_4x4x4_16b_bf16 v[44:47], v[84:85], v[22:23], v[72:75]
    v_exp_f32 v53, v97
    v_exp_f32 v54, v98
    v_exp_f32 v55, v99
    v_exp_f32 v56, v100
    v_mfma_f32_32x32x16_bf16 v[32:47], v[64:67], v[68:71], v[32:47]
    v_exp_f32 v57, v101
    v_exp_f32 v58, v102
    v_exp_f32 v59, v103
    v_exp_f32 v60, v104
    v_exp_f32 v61, v105
    buffer_load_dword v16, v8, s[8:11], 0 offen
    buffer_load_dword v17, v12, s[8:11], 0 offen
    buffer_load_dword v18, v9, s[8:11], 0 offen
    buffer_load_dword v19, v13, s[8:11], 0 offen
    buffer_load_dword v20, v10, s[8:11], 0 offen
    buffer_load_dword v21, v14, s[8:11], 0 offen
    buffer_load_dword v22, v11, s[8:11], 0 offen
    buffer_load_dword v23, v15, s[8:11], 0 offen
    ds_read_b128 v[8:11], v86 offset:128
    ds_read_b128 v[12:15], v87 offset:128
    ds_read2_b64 v[64:67], v88 offset0:28 offset1:28
    v_exp_f32 v62, v106
    v_exp_f32 v63, v107
    v_pk_fma_f32 v[80:81], v[80:81], v[48:49], v[80:81]
    v_pk_fma_f32 v[82:83], v[82:83], v[50:51], v[82:83]
    v_pk_fma_f32 v[80:81], v[92:93], v[76:77], v[80:81]
    v_pk_fma_f32 v[82:83], v[94:95], v[78:79], v[82:83]
    v_pk_fma_f32 v[76:77], v[76:77], v[48:49], v[76:77]
    v_pk_fma_f32 v[78:79], v[78:79], v[50:51], v[78:79]
    v_pk_fma_f32 v[80:81], v[80:81], v[52:53], v[80:81]
    v_pk_fma_f32 v[82:83], v[82:83], v[54:55], v[82:83]
    v_pk_fma_f32 v[80:81], v[96:97], v[76:77], v[80:81]
    v_pk_fma_f32 v[82:83], v[98:99], v[78:79], v[82:83]
    v_pk_fma_f32 v[76:77], v[76:77], v[52:53], v[76:77]
    v_pk_fma_f32 v[78:79], v[78:79], v[54:55], v[78:79]
    v_pk_fma_f32 v[80:81], v[80:81], v[56:57], v[80:81]
    v_pk_fma_f32 v[82:83], v[82:83], v[58:59], v[82:83]
    v_pk_fma_f32 v[80:81], v[100:101], v[76:77], v[80:81]
    v_pk_fma_f32 v[82:83], v[102:103], v[78:79], v[82:83]
    v_pk_fma_f32 v[76:77], v[76:77], v[56:57], v[76:77]
    v_pk_fma_f32 v[78:79], v[78:79], v[58:59], v[78:79]
    v_pk_fma_f32 v[80:81], v[80:81], v[60:61], v[80:81]
    v_pk_fma_f32 v[82:83], v[82:83], v[62:63], v[82:83]
    v_pk_fma_f32 v[80:81], v[104:105], v[76:77], v[80:81]
    v_pk_fma_f32 v[82:83], v[106:107], v[78:79], v[82:83]
    v_pk_fma_f32 v[76:77], v[76:77], v[60:61], v[76:77]
    v_pk_fma_f32 v[78:79], v[78:79], v[62:63], v[78:79]
    s_bitcmp1_b32 s32, 5
    s_cbranch_scc1 K2_EV5_0
K2_EB5_0:
    s_bitcmp1_b32 s33, 5
    s_cbranch_scc1 K2_EV5_1
K2_EB5_1:
K2_T6:
    v_exp_f32 v48, v32
    v_exp_f32 v49, v33
    s_waitcnt vmcnt(0) lgkmcnt(0)
    v_mfma_f32_4x4x4_16b_bf16 v[92:95], v[84:85], v[16:17], v[72:75]
    v_exp_f32 v50, v34
    v_mfma_f32_4x4x4_16b_bf16 v[96:99], v[84:85], v[18:19], v[72:75]
    v_exp_f32 v51, v35
    v_mfma_f32_4x4x4_16b_bf16 v[100:103], v[84:85], v[20:21], v[72:75]
    v_exp_f32 v52, v36
    v_mfma_f32_4x4x4_16b_bf16 v[104:107], v[84:85], v[22:23], v[72:75]
    v_exp_f32 v53, v37
    v_exp_f32 v54, v38
    v_exp_f32 v55, v39
    v_exp_f32 v56, v40
    v_mfma_f32_32x32x16_bf16 v[92:107], v[64:67], v[68:71], v[92:107]
    v_exp_f32 v57, v41
    v_exp_f32 v58, v42
    v_exp_f32 v59, v43
    v_exp_f32 v60, v44
    v_exp_f32 v61, v45
    buffer_load_dword v16, v8, s[8:11], 0 offen
    buffer_load_dword v17, v12, s[8:11], 0 offen
    buffer_load_dword v18, v9, s[8:11], 0 offen
    buffer_load_dword v19, v13, s[8:11], 0 offen
    buffer_load_dword v20, v10, s[8:11], 0 offen
    buffer_load_dword v21, v14, s[8:11], 0 offen
    buffer_load_dword v22, v11, s[8:11], 0 offen
    buffer_load_dword v23, v15, s[8:11], 0 offen
    ds_read_b128 v[8:11], v86 offset:144
    ds_read_b128 v[12:15], v87 offset:144
    ds_read2_b64 v[64:67], v88 offset0:32 offset1:32
    v_exp_f32 v62, v46
    v_exp_f32 v63, v47
    v_pk_fma_f32 v[80:81], v[80:81], v[48:49], v[80:81]
    v_pk_fma_f32 v[82:83], v[82:83], v[50:51], v[82:83]
    v_pk_fma_f32 v[80:81], v[32:33], v[76:77], v[80:81]
    v_pk_fma_f32 v[82:83], v[34:35], v[78:79], v[82:83]
    v_pk_fma_f32 v[76:77], v[76:77], v[48:49], v[76:77]
    v_pk_fma_f32 v[78:79], v[78:79], v[50:51], v[78:79]
    v_pk_fma_f32 v[80:81], v[80:81], v[52:53], v[80:81]
    v_pk_fma_f32 v[82:83], v[82:83], v[54:55], v[82:83]
    v_pk_fma_f32 v[80:81], v[36:37], v[76:77], v[80:81]
    v_pk_fma_f32 v[82:83], v[38:39], v[78:79], v[82:83]
    v_pk_fma_f32 v[76:77], v[76:77], v[52:53], v[76:77]
    v_pk_fma_f32 v[78:79], v[78:79], v[54:55], v[78:79]
    v_pk_fma_f32 v[80:81], v[80:81], v[56:57], v[80:81]
    v_pk_fma_f32 v[82:83], v[82:83], v[58:59], v[82:83]
    v_pk_fma_f32 v[80:81], v[40:41], v[76:77], v[80:81]
    v_pk_fma_f32 v[82:83], v[42:43], v[78:79], v[82:83]
    v_pk_fma_f32 v[76:77], v[76:77], v[56:57], v[76:77]
    v_pk_fma_f32 v[78:79], v[78:79], v[58:59], v[78:79]
    v_pk_fma_f32 v[80:81], v[80:81], v[60:61], v[80:81]
    v_pk_fma_f32 v[82:83], v[82:83], v[62:63], v[82:83]
    v_pk_fma_f32 v[80:81], v[44:45], v[76:77], v[80:81]
    v_pk_fma_f32 v[82:83], v[46:47], v[78:79], v[82:83]
    v_pk_fma_f32 v[76:77], v[76:77], v[60:61], v[76:77]
    v_pk_fma_f32 v[78:79], v[78:79], v[62:63], v[78:79]
    s_bitcmp1_b32 s32, 6
    s_cbranch_scc1 K2_EV6_0
K2_EB6_0:
    s_bitcmp1_b32 s33, 6
    s_cbranch_scc1 K2_EV6_1
K2_EB6_1:
K2_T7:
    v_exp_f32 v48, v92
    v_exp_f32 v49, v93
    s_waitcnt vmcnt(0) lgkmcnt(0)
    v_mfma_f32_4x4x4_16b_bf16 v[32:35], v[84:85], v[16:17], v[72:75]
    v_exp_f32 v50, v94
    v_mfma_f32_4x4x4_16b_bf16 v[36:39], v[84:85], v[18:19], v[72:75]
    v_exp_f32 v51, v95
    v_mfma_f32_4x4x4_16b_bf16 v[40:43], v[84:85], v[20:21], v[72:75]
    v_exp_f32 v52, v96
    v_mfma_f32_4x4x4_16b_bf16 v[44:47], v[84:85], v[22:23], v[72:75]
    v_exp_f32 v53, v97
    v_exp_f32 v54, v98
    v_exp_f32 v55, v99
    v_exp_f32 v56, v100
    v_mfma_f32_32x32x16_bf16 v[32:47], v[64:67], v[68:71], v[32:47]
    v_exp_f32 v57, v101
    v_exp_f32 v58, v102
    v_exp_f32 v59, v103
    v_exp_f32 v60, v104
    v_exp_f32 v61, v105
    buffer_load_dword v16, v8, s[8:11], 0 offen
    buffer_load_dword v17, v12, s[8:11], 0 offen
    buffer_load_dword v18, v9, s[8:11], 0 offen
    buffer_load_dword v19, v13, s[8:11], 0 offen
    buffer_load_dword v20, v10, s[8:11], 0 offen
    buffer_load_dword v21, v14, s[8:11], 0 offen
    buffer_load_dword v22, v11, s[8:11], 0 offen
    buffer_load_dword v23, v15, s[8:11], 0 offen
    ds_read_b128 v[8:11], v86 offset:160
    ds_read_b128 v[12:15], v87 offset:160
    ds_read2_b64 v[64:67], v88 offset0:36 offset1:36
    v_exp_f32 v62, v106
    v_exp_f32 v63, v107
    v_pk_fma_f32 v[80:81], v[80:81], v[48:49], v[80:81]
    v_pk_fma_f32 v[82:83], v[82:83], v[50:51], v[82:83]
    v_pk_fma_f32 v[80:81], v[92:93], v[76:77], v[80:81]
    v_pk_fma_f32 v[82:83], v[94:95], v[78:79], v[82:83]
    v_pk_fma_f32 v[76:77], v[76:77], v[48:49], v[76:77]
    v_pk_fma_f32 v[78:79], v[78:79], v[50:51], v[78:79]
    v_pk_fma_f32 v[80:81], v[80:81], v[52:53], v[80:81]
    v_pk_fma_f32 v[82:83], v[82:83], v[54:55], v[82:83]
    v_pk_fma_f32 v[80:81], v[96:97], v[76:77], v[80:81]
    v_pk_fma_f32 v[82:83], v[98:99], v[78:79], v[82:83]
    v_pk_fma_f32 v[76:77], v[76:77], v[52:53], v[76:77]
    v_pk_fma_f32 v[78:79], v[78:79], v[54:55], v[78:79]
    v_pk_fma_f32 v[80:81], v[80:81], v[56:57], v[80:81]
    v_pk_fma_f32 v[82:83], v[82:83], v[58:59], v[82:83]
    v_pk_fma_f32 v[80:81], v[100:101], v[76:77], v[80:81]
    v_pk_fma_f32 v[82:83], v[102:103], v[78:79], v[82:83]
    v_pk_fma_f32 v[76:77], v[76:77], v[56:57], v[76:77]
    v_pk_fma_f32 v[78:79], v[78:79], v[58:59], v[78:79]
    v_pk_fma_f32 v[80:81], v[80:81], v[60:61], v[80:81]
    v_pk_fma_f32 v[82:83], v[82:83], v[62:63], v[82:83]
    v_pk_fma_f32 v[80:81], v[104:105], v[76:77], v[80:81]
    v_pk_fma_f32 v[82:83], v[106:107], v[78:79], v[82:83]
    v_pk_fma_f32 v[76:77], v[76:77], v[60:61], v[76:77]
    v_pk_fma_f32 v[78:79], v[78:79], v[62:63], v[78:79]
    s_bitcmp1_b32 s32, 7
    s_cbranch_scc1 K2_EV7_0
K2_EB7_0:
    s_bitcmp1_b32 s33, 7
    s_cbranch_scc1 K2_EV7_1
K2_EB7_1:
K2_T8:
    v_exp_f32 v48, v32
    v_exp_f32 v49, v33
    s_waitcnt vmcnt(0) lgkmcnt(0)
    v_mfma_f32_4x4x4_16b_bf16 v[92:95], v[84:85], v[16:17], v[72:75]
    v_exp_f32 v50, v34
    v_mfma_f32_4x4x4_16b_bf16 v[96:99], v[84:85], v[18:19], v[72:75]
    v_exp_f32 v51, v35
    v_mfma_f32_4x4x4_16b_bf16 v[100:103], v[84:85], v[20:21], v[72:75]
    v_exp_f32 v52, v36
    v_mfma_f32_4x4x4_16b_bf16 v[104:107], v[84:85], v[22:23], v[72:75]
    v_exp_f32 v53, v37
    v_exp_f32 v54, v38
    v_exp_f32 v55, v39
    v_exp_f32 v56, v40
    v_mfma_f32_32x32x16_bf16 v[92:107], v[64:67], v[68:71], v[92:107]
    v_exp_f32 v57, v41
    v_exp_f32 v58, v42
    v_exp_f32 v59, v43
    v_exp_f32 v60, v44
    v_exp_f32 v61, v45
    buffer_load_dword v16, v8, s[8:11], 0 offen
    buffer_load_dword v17, v12, s[8:11], 0 offen
    buffer_load_dword v18, v9, s[8:11], 0 offen
    buffer_load_dword v19, v13, s[8:11], 0 offen
    buffer_load_dword v20, v10, s[8:11], 0 offen
    buffer_load_dword v21, v14, s[8:11], 0 offen
    buffer_load_dword v22, v11, s[8:11], 0 offen
    buffer_load_dword v23, v15, s[8:11], 0 offen
    ds_read_b128 v[8:11], v86 offset:176
    ds_read_b128 v[12:15], v87 offset:176
    ds_read2_b64 v[64:67], v88 offset0:40 offset1:40
    v_exp_f32 v62, v46
    v_exp_f32 v63, v47
    v_pk_fma_f32 v[80:81], v[80:81], v[48:49], v[80:81]
    v_pk_fma_f32 v[82:83], v[82:83], v[50:51], v[82:83]
    v_pk_fma_f32 v[80:81], v[32:33], v[76:77], v[80:81]
    v_pk_fma_f32 v[82:83], v[34:35], v[78:79], v[82:83]
    v_pk_fma_f32 v[76:77], v[76:77], v[48:49], v[76:77]
    v_pk_fma_f32 v[78:79], v[78:79], v[50:51], v[78:79]
    v_pk_fma_f32 v[80:81], v[80:81], v[52:53], v[80:81]
    v_pk_fma_f32 v[82:83], v[82:83], v[54:55], v[82:83]
    v_pk_fma_f32 v[80:81], v[36:37], v[76:77], v[80:81]
    v_pk_fma_f32 v[82:83], v[38:39], v[78:79], v[82:83]
    v_pk_fma_f32 v[76:77], v[76:77], v[52:53], v[76:77]
    v_pk_fma_f32 v[78:79], v[78:79], v[54:55], v[78:79]
    v_pk_fma_f32 v[80:81], v[80:81], v[56:57], v[80:81]
    v_pk_fma_f32 v[82:83], v[82:83], v[58:59], v[82:83]
    v_pk_fma_f32 v[80:81], v[40:41], v[76:77], v[80:81]
    v_pk_fma_f32 v[82:83], v[42:43], v[78:79], v[82:83]
    v_pk_fma_f32 v[76:77], v[76:77], v[56:57], v[76:77]
    v_pk_fma_f32 v[78:79], v[78:79], v[58:59], v[78:79]
    v_pk_fma_f32 v[80:81], v[80:81], v[60:61], v[80:81]
    v_pk_fma_f32 v[82:83], v[82:83], v[62:63], v[82:83]
    v_pk_fma_f32 v[80:81], v[44:45], v[76:77], v[80:81]
    v_pk_fma_f32 v[82:83], v[46:47], v[78:79], v[82:83]
    v_pk_fma_f32 v[76:77], v[76:77], v[60:61], v[76:77]
    v_pk_fma_f32 v[78:79], v[78:79], v[62:63], v[78:79]
    s_bitcmp1_b32 s32, 8
    s_cbranch_scc1 K2_EV8_0
K2_EB8_0:
    s_bitcmp1_b32 s33, 8
    s_cbranch_scc1 K2_EV8_1
K2_EB8_1:
K2_T9:
    v_exp_f32 v48, v92
    v_exp_f32 v49, v93
    s_waitcnt vmcnt(0) lgkmcnt(0)
    v_mfma_f32_4x4x4_16b_bf16 v[32:35], v[84:85], v[16:17], v[72:75]
    v_exp_f32 v50, v94
    v_mfma_f32_4x4x4_16b_bf16 v[36:39], v[84:85], v[18:19], v[72:75]
    v_exp_f32 v51, v95
    v_mfma_f32_4x4x4_16b_bf16 v[40:43], v[84:85], v[20:21], v[72:75]
    v_exp_f32 v52, v96
    v_mfma_f32_4x4x4_16b_bf16 v[44:47], v[84:85], v[22:23], v[72:75]
    v_exp_f32 v53, v97
    v_exp_f32 v54, v98
    v_exp_f32 v55, v99
    v_exp_f32 v56, v100
    v_mfma_f32_32x32x16_bf16 v[32:47], v[64:67], v[68:71], v[32:47]
    v_exp_f32 v57, v101
    v_exp_f32 v58, v102
    v_exp_f32 v59, v103
    v_exp_f32 v60, v104
    v_exp_f32 v61, v105
    buffer_load_dword v16, v8, s[8:11], 0 offen
    buffer_load_dword v17, v12, s[8:11], 0 offen
    buffer_load_dword v18, v9, s[8:11], 0 offen
    buffer_load_dword v19, v13, s[8:11], 0 offen
    buffer_load_dword v20, v10, s[8:11], 0 offen
    buffer_load_dword v21, v14, s[8:11], 0 offen
    buffer_load_dword v22, v11, s[8:11], 0 offen
    buffer_load_dword v23, v15, s[8:11], 0 offen
    ds_read_b128 v[8:11], v86 offset:192
    ds_read_b128 v[12:15], v87 offset:192
    ds_read2_b64 v[64:67], v88 offset0:44 offset1:44
    v_exp_f32 v62, v106
    v_exp_f32 v63, v107
    v_pk_fma_f32 v[80:81], v[80:81], v[48:49], v[80:81]
    v_pk_fma_f32 v[82:83], v[82:83], v[50:51], v[82:83]
    v_pk_fma_f32 v[80:81], v[92:93], v[76:77], v[80:81]
    v_pk_fma_f32 v[82:83], v[94:95], v[78:79], v[82:83]
    v_pk_fma_f32 v[76:77], v[76:77], v[48:49], v[76:77]
    v_pk_fma_f32 v[78:79], v[78:79], v[50:51], v[78:79]
    v_pk_fma_f32 v[80:81], v[80:81], v[52:53], v[80:81]
    v_pk_fma_f32 v[82:83], v[82:83], v[54:55], v[82:83]
    v_pk_fma_f32 v[80:81], v[96:97], v[76:77], v[80:81]
    v_pk_fma_f32 v[82:83], v[98:99], v[78:79], v[82:83]
    v_pk_fma_f32 v[76:77], v[76:77], v[52:53], v[76:77]
    v_pk_fma_f32 v[78:79], v[78:79], v[54:55], v[78:79]
    v_pk_fma_f32 v[80:81], v[80:81], v[56:57], v[80:81]
    v_pk_fma_f32 v[82:83], v[82:83], v[58:59], v[82:83]
    v_pk_fma_f32 v[80:81], v[100:101], v[76:77], v[80:81]
    v_pk_fma_f32 v[82:83], v[102:103], v[78:79], v[82:83]
    v_pk_fma_f32 v[76:77], v[76:77], v[56:57], v[76:77]
    v_pk_fma_f32 v[78:79], v[78:79], v[58:59], v[78:79]
    v_pk_fma_f32 v[80:81], v[80:81], v[60:61], v[80:81]
    v_pk_fma_f32 v[82:83], v[82:83], v[62:63], v[82:83]
    v_pk_fma_f32 v[80:81], v[104:105], v[76:77], v[80:81]
    v_pk_fma_f32 v[82:83], v[106:107], v[78:79], v[82:83]
    v_pk_fma_f32 v[76:77], v[76:77], v[60:61], v[76:77]
    v_pk_fma_f32 v[78:79], v[78:79], v[62:63], v[78:79]
    s_bitcmp1_b32 s32, 9
    s_cbranch_scc1 K2_EV9_0
K2_EB9_0:
    s_bitcmp1_b32 s33, 9
    s_cbranch_scc1 K2_EV9_1
K2_EB9_1:
K2_T10:
    v_exp_f32 v48, v32
    v_exp_f32 v49, v33
    s_waitcnt vmcnt(0) lgkmcnt(0)
    v_mfma_f32_4x4x4_16b_bf16 v[92:95], v[84:85], v[16:17], v[72:75]
    v_exp_f32 v50, v34
    v_mfma_f32_4x4x4_16b_bf16 v[96:99], v[84:85], v[18:19], v[72:75]
    v_exp_f32 v51, v35
    v_mfma_f32_4x4x4_16b_bf16 v[100:103], v[84:85], v[20:21], v[72:75]
    v_exp_f32 v52, v36
    v_mfma_f32_4x4x4_16b_bf16 v[104:107], v[84:85], v[22:23], v[72:75]
    v_exp_f32 v53, v37
    v_exp_f32 v54, v38
    v_exp_f32 v55, v39
    v_exp_f32 v56, v40
    v_mfma_f32_32x32x16_bf16 v[92:107], v[64:67], v[68:71], v[92:107]
    v_exp_f32 v57, v41
    v_exp_f32 v58, v42
    v_exp_f32 v59, v43
    v_exp_f32 v60, v44
    v_exp_f32 v61, v45
    buffer_load_dword v16, v8, s[8:11], 0 offen
    buffer_load_dword v17, v12, s[8:11], 0 offen
    buffer_load_dword v18, v9, s[8:11], 0 offen
    buffer_load_dword v19, v13, s[8:11], 0 offen
    buffer_load_dword v20, v10, s[8:11], 0 offen
    buffer_load_dword v21, v14, s[8:11], 0 offen
    buffer_load_dword v22, v11, s[8:11], 0 offen
    buffer_load_dword v23, v15, s[8:11], 0 offen
    ds_read_b128 v[8:11], v86 offset:208
    ds_read_b128 v[12:15], v87 offset:208
    ds_read2_b64 v[64:67], v88 offset0:48 offset1:48
    v_exp_f32 v62, v46
    v_exp_f32 v63, v47
    v_pk_fma_f32 v[80:81], v[80:81], v[48:49], v[80:81]
    v_pk_fma_f32 v[82:83], v[82:83], v[50:51], v[82:83]
    v_pk_fma_f32 v[80:81], v[32:33], v[76:77], v[80:81]
    v_pk_fma_f32 v[82:83], v[34:35], v[78:79], v[82:83]
    v_pk_fma_f32 v[76:77], v[76:77], v[48:49], v[76:77]
    v_pk_fma_f32 v[78:79], v[78:79], v[50:51], v[78:79]
    v_pk_fma_f32 v[80:81], v[80:81], v[52:53], v[80:81]
    v_pk_fma_f32 v[82:83], v[82:83], v[54:55], v[82:83]
    v_pk_fma_f32 v[80:81], v[36:37], v[76:77], v[80:81]
    v_pk_fma_f32 v[82:83], v[38:39], v[78:79], v[82:83]
    v_pk_fma_f32 v[76:77], v[76:77], v[52:53], v[76:77]
    v_pk_fma_f32 v[78:79], v[78:79], v[54:55], v[78:79]
    v_pk_fma_f32 v[80:81], v[80:81], v[56:57], v[80:81]
    v_pk_fma_f32 v[82:83], v[82:83], v[58:59], v[82:83]
    v_pk_fma_f32 v[80:81], v[40:41], v[76:77], v[80:81]
    v_pk_fma_f32 v[82:83], v[42:43], v[78:79], v[82:83]
    v_pk_fma_f32 v[76:77], v[76:77], v[56:57], v[76:77]
    v_pk_fma_f32 v[78:79], v[78:79], v[58:59], v[78:79]
    v_pk_fma_f32 v[80:81], v[80:81], v[60:61], v[80:81]
    v_pk_fma_f32 v[82:83], v[82:83], v[62:63], v[82:83]
    v_pk_fma_f32 v[80:81], v[44:45], v[76:77], v[80:81]
    v_pk_fma_f32 v[82:83], v[46:47], v[78:79], v[82:83]
    v_pk_fma_f32 v[76:77], v[76:77], v[60:61], v[76:77]
    v_pk_fma_f32 v[78:79], v[78:79], v[62:63], v[78:79]
    s_bitcmp1_b32 s32, 10
    s_cbranch_scc1 K2_EV10_0
K2_EB10_0:
    s_bitcmp1_b32 s33, 10
    s_cbranch_scc1 K2_EV10_1
K2_EB10_1:
K2_T11:
    v_exp_f32 v48, v92
    v_exp_f32 v49, v93
    s_waitcnt vmcnt(0) lgkmcnt(0)
    v_mfma_f32_4x4x4_16b_bf16 v[32:35], v[84:85], v[16:17], v[72:75]
    v_exp_f32 v50, v94
    v_mfma_f32_4x4x4_16b_bf16 v[36:39], v[84:85], v[18:19], v[72:75]
    v_exp_f32 v51, v95
    v_mfma_f32_4x4x4_16b_bf16 v[40:43], v[84:85], v[20:21], v[72:75]
    v_exp_f32 v52, v96
    v_mfma_f32_4x4x4_16b_bf16 v[44:47], v[84:85], v[22:23], v[72:75]
    v_exp_f32 v53, v97
    v_exp_f32 v54, v98
    v_exp_f32 v55, v99
    v_exp_f32 v56, v100
    v_mfma_f32_32x32x16_bf16 v[32:47], v[64:67], v[68:71], v[32:47]
    v_exp_f32 v57, v101
    v_exp_f32 v58, v102
    v_exp_f32 v59, v103
    v_exp_f32 v60, v104
    v_exp_f32 v61, v105
    buffer_load_dword v16, v8, s[8:11], 0 offen
    buffer_load_dword v17, v12, s[8:11], 0 offen
    buffer_load_dword v18, v9, s[8:11], 0 offen
    buffer_load_dword v19, v13, s[8:11], 0 offen
    buffer_load_dword v20, v10, s[8:11], 0 offen
    buffer_load_dword v21, v14, s[8:11], 0 offen
    buffer_load_dword v22, v11, s[8:11], 0 offen
    buffer_load_dword v23, v15, s[8:11], 0 offen
    ds_read_b128 v[8:11], v86 offset:224
    ds_read_b128 v[12:15], v87 offset:224
    ds_read2_b64 v[64:67], v88 offset0:52 offset1:52
    v_exp_f32 v62, v106
    v_exp_f32 v63, v107
    v_pk_fma_f32 v[80:81], v[80:81], v[48:49], v[80:81]
    v_pk_fma_f32 v[82:83], v[82:83], v[50:51], v[82:83]
    v_pk_fma_f32 v[80:81], v[92:93], v[76:77], v[80:81]
    v_pk_fma_f32 v[82:83], v[94:95], v[78:79], v[82:83]
    v_pk_fma_f32 v[76:77], v[76:77], v[48:49], v[76:77]
    v_pk_fma_f32 v[78:79], v[78:79], v[50:51], v[78:79]
    v_pk_fma_f32 v[80:81], v[80:81], v[52:53], v[80:81]
    v_pk_fma_f32 v[82:83], v[82:83], v[54:55], v[82:83]
    v_pk_fma_f32 v[80:81], v[96:97], v[76:77], v[80:81]
    v_pk_fma_f32 v[82:83], v[98:99], v[78:79], v[82:83]
    v_pk_fma_f32 v[76:77], v[76:77], v[52:53], v[76:77]
    v_pk_fma_f32 v[78:79], v[78:79], v[54:55], v[78:79]
    v_pk_fma_f32 v[80:81], v[80:81], v[56:57], v[80:81]
    v_pk_fma_f32 v[82:83], v[82:83], v[58:59], v[82:83]
    v_pk_fma_f32 v[80:81], v[100:101], v[76:77], v[80:81]
    v_pk_fma_f32 v[82:83], v[102:103], v[78:79], v[82:83]
    v_pk_fma_f32 v[76:77], v[76:77], v[56:57], v[76:77]
    v_pk_fma_f32 v[78:79], v[78:79], v[58:59], v[78:79]
    v_pk_fma_f32 v[80:81], v[80:81], v[60:61], v[80:81]
    v_pk_fma_f32 v[82:83], v[82:83], v[62:63], v[82:83]
    v_pk_fma_f32 v[80:81], v[104:105], v[76:77], v[80:81]
    v_pk_fma_f32 v[82:83], v[106:107], v[78:79], v[82:83]
    v_pk_fma_f32 v[76:77], v[76:77], v[60:61], v[76:77]
    v_pk_fma_f32 v[78:79], v[78:79], v[62:63], v[78:79]
    s_bitcmp1_b32 s32, 11
    s_cbranch_scc1 K2_EV11_0
K2_EB11_0:
    s_bitcmp1_b32 s33, 11
    s_cbranch_scc1 K2_EV11_1
K2_EB11_1:
K2_T12:
    s_setprio 1
    v_exp_f32 v48, v32
    v_exp_f32 v49, v33
    s_waitcnt vmcnt(0) lgkmcnt(0)
    v_mfma_f32_4x4x4_16b_bf16 v[92:95], v[84:85], v[16:17], v[72:75]
    v_exp_f32 v50, v34
    v_mfma_f32_4x4x4_16b_bf16 v[96:99], v[84:85], v[18:19], v[72:75]
    v_exp_f32 v51, v35
    v_mfma_f32_4x4x4_16b_bf16 v[100:103], v[84:85], v[20:21], v[72:75]
    v_exp_f32 v52, v36
    v_mfma_f32_4x4x4_16b_bf16 v[104:107], v[84:85], v[22:23], v[72:75]
    v_exp_f32 v53, v37
    v_exp_f32 v54, v38
    v_exp_f32 v55, v39
    v_exp_f32 v56, v40
    v_mfma_f32_32x32x16_bf16 v[92:107], v[64:67], v[68:71], v[92:107]
    v_exp_f32 v57, v41
    v_exp_f32 v58, v42
    v_exp_f32 v59, v43
    v_exp_f32 v60, v44
    v_exp_f32 v61, v45
    buffer_load_dword v16, v8, s[8:11], 0 offen
    buffer_load_dword v17, v12, s[8:11], 0 offen
    buffer_load_dword v18, v9, s[8:11], 0 offen
    buffer_load_dword v19, v13, s[8:11], 0 offen
    buffer_load_dword v20, v10, s[8:11], 0 offen
    buffer_load_dword v21, v14, s[8:11], 0 offen
    buffer_load_dword v22, v11, s[8:11], 0 offen
    buffer_load_dword v23, v15, s[8:11], 0 offen
    ds_read_b128 v[8:11], v86 offset:240
    ds_read_b128 v[12:15], v87 offset:240
    ds_read2_b64 v[64:67], v88 offset0:56 offset1:56
    v_exp_f32 v62, v46
    v_exp_f32 v63, v47
    v_pk_fma_f32 v[80:81], v[80:81], v[48:49], v[80:81]
    v_pk_fma_f32 v[82:83], v[82:83], v[50:51], v[82:83]
    v_pk_fma_f32 v[80:81], v[32:33], v[76:77], v[80:81]
    v_pk_fma_f32 v[82:83], v[34:35], v[78:79], v[82:83]
    v_pk_fma_f32 v[76:77], v[76:77], v[48:49], v[76:77]
    v_pk_fma_f32 v[78:79], v[78:79], v[50:51], v[78:79]
    v_pk_fma_f32 v[80:81], v[80:81], v[52:53], v[80:81]
    v_pk_fma_f32 v[82:83], v[82:83], v[54:55], v[82:83]
    v_pk_fma_f32 v[80:81], v[36:37], v[76:77], v[80:81]
    v_pk_fma_f32 v[82:83], v[38:39], v[78:79], v[82:83]
    v_pk_fma_f32 v[76:77], v[76:77], v[52:53], v[76:77]
    v_pk_fma_f32 v[78:79], v[78:79], v[54:55], v[78:79]
    v_pk_fma_f32 v[80:81], v[80:81], v[56:57], v[80:81]
    v_pk_fma_f32 v[82:83], v[82:83], v[58:59], v[82:83]
    v_pk_fma_f32 v[80:81], v[40:41], v[76:77], v[80:81]
    v_pk_fma_f32 v[82:83], v[42:43], v[78:79], v[82:83]
    v_pk_fma_f32 v[76:77], v[76:77], v[56:57], v[76:77]
    v_pk_fma_f32 v[78:79], v[78:79], v[58:59], v[78:79]
    v_pk_fma_f32 v[80:81], v[80:81], v[60:61], v[80:81]
    v_pk_fma_f32 v[82:83], v[82:83], v[62:63], v[82:83]
    v_pk_fma_f32 v[80:81], v[44:45], v[76:77], v[80:81]
    v_pk_fma_f32 v[82:83], v[46:47], v[78:79], v[82:83]
    v_pk_fma_f32 v[76:77], v[76:77], v[60:61], v[76:77]
    v_pk_fma_f32 v[78:79], v[78:79], v[62:63], v[78:79]
    s_bitcmp1_b32 s32, 12
    s_cbranch_scc1 K2_EV12_0
K2_EB12_0:
    s_bitcmp1_b32 s33, 12
    s_cbranch_scc1 K2_EV12_1
K2_EB12_1:
K2_T13:
    v_exp_f32 v48, v92
    v_exp_f32 v49, v93
    s_waitcnt vmcnt(0) lgkmcnt(0)
    v_mfma_f32_4x4x4_16b_bf16 v[32:35], v[84:85], v[16:17], v[72:75]
    v_exp_f32 v50, v94
    v_mfma_f32_4x4x4_16b_bf16 v[36:39], v[84:85], v[18:19], v[72:75]
    v_exp_f32 v51, v95
    v_mfma_f32_4x4x4_16b_bf16 v[40:43], v[84:85], v[20:21], v[72:75]
    v_exp_f32 v52, v96
    v_mfma_f32_4x4x4_16b_bf16 v[44:47], v[84:85], v[22:23], v[72:75]
    v_exp_f32 v53, v97
    v_exp_f32 v54, v98
    v_exp_f32 v55, v99
    v_exp_f32 v56, v100
    v_mfma_f32_32x32x16_bf16 v[32:47], v[64:67], v[68:71], v[32:47]
    v_exp_f32 v57, v101
    v_exp_f32 v58, v102
    v_exp_f32 v59, v103
    v_exp_f32 v60, v104
    v_exp_f32 v61, v105
    buffer_load_dword v16, v8, s[8:11], 0 offen
    buffer_load_dword v17, v12, s[8:11], 0 offen
    buffer_load_dword v18, v9, s[8:11], 0 offen
    buffer_load_dword v19, v13, s[8:11], 0 offen
    buffer_load_dword v20, v10, s[8:11], 0 offen
    buffer_load_dword v21, v14, s[8:11], 0 offen
    buffer_load_dword v22, v11, s[8:11], 0 offen
    buffer_load_dword v23, v15, s[8:11], 0 offen
    ds_read2_b64 v[64:67], v88 offset0:60 offset1:60
    v_exp_f32 v62, v106
    v_exp_f32 v63, v107
    v_pk_fma_f32 v[80:81], v[80:81], v[48:49], v[80:81]
    v_pk_fma_f32 v[82:83], v[82:83], v[50:51], v[82:83]
    v_pk_fma_f32 v[80:81], v[92:93], v[76:77], v[80:81]
    v_pk_fma_f32 v[82:83], v[94:95], v[78:79], v[82:83]
    v_pk_fma_f32 v[76:77], v[76:77], v[48:49], v[76:77]
    v_pk_fma_f32 v[78:79], v[78:79], v[50:51], v[78:79]
    v_pk_fma_f32 v[80:81], v[80:81], v[52:53], v[80:81]
    v_pk_fma_f32 v[82:83], v[82:83], v[54:55], v[82:83]
    v_pk_fma_f32 v[80:81], v[96:97], v[76:77], v[80:81]
    v_pk_fma_f32 v[82:83], v[98:99], v[78:79], v[82:83]
    v_pk_fma_f32 v[76:77], v[76:77], v[52:53], v[76:77]
    v_pk_fma_f32 v[78:79], v[78:79], v[54:55], v[78:79]
    v_pk_fma_f32 v[80:81], v[80:81], v[56:57], v[80:81]
    v_pk_fma_f32 v[82:83], v[82:83], v[58:59], v[82:83]
    v_pk_fma_f32 v[80:81], v[100:101], v[76:77], v[80:81]
    v_pk_fma_f32 v[82:83], v[102:103], v[78:79], v[82:83]
    v_pk_fma_f32 v[76:77], v[76:77], v[56:57], v[76:77]
    v_pk_fma_f32 v[78:79], v[78:79], v[58:59], v[78:79]
    v_pk_fma_f32 v[80:81], v[80:81], v[60:61], v[80:81]
    v_pk_fma_f32 v[82:83], v[82:83], v[62:63], v[82:83]
    v_pk_fma_f32 v[80:81], v[104:105], v[76:77], v[80:81]
    v_pk_fma_f32 v[82:83], v[106:107], v[78:79], v[82:83]
    v_pk_fma_f32 v[76:77], v[76:77], v[60:61], v[76:77]
    v_pk_fma_f32 v[78:79], v[78:79], v[62:63], v[78:79]
    s_bitcmp1_b32 s32, 13
    s_cbranch_scc1 K2_EV13_0
K2_EB13_0:
    s_bitcmp1_b32 s33, 13
    s_cbranch_scc1 K2_EV13_1
K2_EB13_1:
K2_T14:
    v_exp_f32 v48, v32
    v_exp_f32 v49, v33
    s_waitcnt vmcnt(0) lgkmcnt(0)
    v_mfma_f32_4x4x4_16b_bf16 v[92:95], v[84:85], v[16:17], v[72:75]
    v_exp_f32 v50, v34
    v_mfma_f32_4x4x4_16b_bf16 v[96:99], v[84:85], v[18:19], v[72:75]
    v_exp_f32 v51, v35
    v_mfma_f32_4x4x4_16b_bf16 v[100:103], v[84:85], v[20:21], v[72:75]
    v_exp_f32 v52, v36
    v_mfma_f32_4x4x4_16b_bf16 v[104:107], v[84:85], v[22:23], v[72:75]
    v_exp_f32 v53, v37
    v_exp_f32 v54, v38
    v_exp_f32 v55, v39
    v_exp_f32 v56, v40
    v_mfma_f32_32x32x16_bf16 v[92:107], v[64:67], v[68:71], v[92:107]
    v_exp_f32 v57, v41
    v_exp_f32 v58, v42
    v_exp_f32 v59, v43
    v_exp_f32 v60, v44
    v_exp_f32 v61, v45
    v_exp_f32 v62, v46
    v_exp_f32 v63, v47
    v_pk_fma_f32 v[80:81], v[80:81], v[48:49], v[80:81]
    v_pk_fma_f32 v[82:83], v[82:83], v[50:51], v[82:83]
    v_pk_fma_f32 v[80:81], v[32:33], v[76:77], v[80:81]
    v_pk_fma_f32 v[82:83], v[34:35], v[78:79], v[82:83]
    v_pk_fma_f32 v[76:77], v[76:77], v[48:49], v[76:77]
    v_pk_fma_f32 v[78:79], v[78:79], v[50:51], v[78:79]
    v_pk_fma_f32 v[80:81], v[80:81], v[52:53], v[80:81]
    v_pk_fma_f32 v[82:83], v[82:83], v[54:55], v[82:83]
    v_pk_fma_f32 v[80:81], v[36:37], v[76:77], v[80:81]
    v_pk_fma_f32 v[82:83], v[38:39], v[78:79], v[82:83]
    v_pk_fma_f32 v[76:77], v[76:77], v[52:53], v[76:77]
    v_pk_fma_f32 v[78:79], v[78:79], v[54:55], v[78:79]
    v_pk_fma_f32 v[80:81], v[80:81], v[56:57], v[80:81]
    v_pk_fma_f32 v[82:83], v[82:83], v[58:59], v[82:83]
    v_pk_fma_f32 v[80:81], v[40:41], v[76:77], v[80:81]
    v_pk_fma_f32 v[82:83], v[42:43], v[78:79], v[82:83]
    v_pk_fma_f32 v[76:77], v[76:77], v[56:57], v[76:77]
    v_pk_fma_f32 v[78:79], v[78:79], v[58:59], v[78:79]
    v_pk_fma_f32 v[80:81], v[80:81], v[60:61], v[80:81]
    v_pk_fma_f32 v[82:83], v[82:83], v[62:63], v[82:83]
    v_pk_fma_f32 v[80:81], v[44:45], v[76:77], v[80:81]
    v_pk_fma_f32 v[82:83], v[46:47], v[78:79], v[82:83]
    v_pk_fma_f32 v[76:77], v[76:77], v[60:61], v[76:77]
    v_pk_fma_f32 v[78:79], v[78:79], v[62:63], v[78:79]
    s_bitcmp1_b32 s32, 14
    s_cbranch_scc1 K2_EV14_0
K2_EB14_0:
    s_bitcmp1_b32 s33, 14
    s_cbranch_scc1 K2_EV14_1
K2_EB14_1:
K2_T15:
    s_setprio 0
    v_exp_f32 v48, v92
    v_exp_f32 v49, v93
    v_exp_f32 v50, v94
    v_exp_f32 v51, v95
    v_exp_f32 v52, v96
    v_exp_f32 v53, v97
    v_exp_f32 v54, v98
    v_exp_f32 v55, v99
    v_exp_f32 v56, v100
    v_exp_f32 v57, v101
    v_exp_f32 v58, v102
    v_exp_f32 v59, v103
    v_exp_f32 v60, v104
    v_exp_f32 v61, v105
    v_exp_f32 v62, v106
    v_exp_f32 v63, v107
    v_pk_fma_f32 v[80:81], v[80:81], v[48:49], v[80:81]
    v_pk_fma_f32 v[82:83], v[82:83], v[50:51], v[82:83]
    v_pk_fma_f32 v[80:81], v[92:93], v[76:77], v[80:81]
    v_pk_fma_f32 v[82:83], v[94:95], v[78:79], v[82:83]
    v_pk_fma_f32 v[76:77], v[76:77], v[48:49], v[76:77]
    v_pk_fma_f32 v[78:79], v[78:79], v[50:51], v[78:79]
    v_pk_fma_f32 v[80:81], v[80:81], v[52:53], v[80:81]
    v_pk_fma_f32 v[82:83], v[82:83], v[54:55], v[82:83]
    v_pk_fma_f32 v[80:81], v[96:97], v[76:77], v[80:81]
    v_pk_fma_f32 v[82:83], v[98:99], v[78:79], v[82:83]
    v_pk_fma_f32 v[76:77], v[76:77], v[52:53], v[76:77]
    v_pk_fma_f32 v[78:79], v[78:79], v[54:55], v[78:79]
    v_pk_fma_f32 v[80:81], v[80:81], v[56:57], v[80:81]
    v_pk_fma_f32 v[82:83], v[82:83], v[58:59], v[82:83]
    v_pk_fma_f32 v[80:81], v[100:101], v[76:77], v[80:81]
    v_pk_fma_f32 v[82:83], v[102:103], v[78:79], v[82:83]
    v_pk_fma_f32 v[76:77], v[76:77], v[56:57], v[76:77]
    v_pk_fma_f32 v[78:79], v[78:79], v[58:59], v[78:79]
    v_pk_fma_f32 v[80:81], v[80:81], v[60:61], v[80:81]
    v_pk_fma_f32 v[82:83], v[82:83], v[62:63], v[82:83]
    v_pk_fma_f32 v[80:81], v[104:105], v[76:77], v[80:81]
    v_pk_fma_f32 v[82:83], v[106:107], v[78:79], v[82:83]
    v_pk_fma_f32 v[76:77], v[76:77], v[60:61], v[76:77]
    v_pk_fma_f32 v[78:79], v[78:79], v[62:63], v[78:79]
K2_LDIV:
    v_rcp_f32 v52, v76
    v_rcp_f32 v53, v77
    v_pk_add_f32 v[120:121], v[120:121], v[76:77]
    v_pk_mul_f32 v[80:81], v[80:81], v[52:53]
    v_pk_fma_f32 v[120:121], v[80:81], v[80:81], v[120:121]
    v_rcp_f32 v60, v78
    v_rcp_f32 v61, v79
    v_pk_add_f32 v[120:121], v[120:121], v[78:79]
    v_pk_mul_f32 v[82:83], v[82:83], v[60:61]
    v_pk_fma_f32 v[120:121], v[82:83], v[82:83], v[120:121]
K2_LDONE:
    s_cmp_ge_u32 s21, 8
    s_cbranch_scc1 K2_LD2
    s_lshl_b32 s36, s21, 12
    s_add_u32 s36, s36, 6914048
    s_add_u32 s37, s36, 32768
    buffer_load_dwordx4 v[16:19], v7, s[4:7], s36 offen offset:0
    buffer_load_dwordx4 v[20:23], v7, s[4:7], s36 offen offset:1024
    buffer_load_dwordx4 v[24:27], v7, s[4:7], s36 offen offset:2048
    buffer_load_dwordx4 v[28:31], v7, s[4:7], s36 offen offset:3072
    buffer_load_dwordx4 v[92:95], v7, s[4:7], s37 offen offset:0
    buffer_load_dwordx4 v[96:99], v7, s[4:7], s37 offen offset:1024
    buffer_load_dwordx4 v[100:103], v7, s[4:7], s37 offen offset:2048
    buffer_load_dwordx4 v[104:107], v7, s[4:7], s37 offen offset:3072
K2_LD2:
    v_cvt_f64_f32 v[48:49], v80
    v_cvt_f64_f32 v[50:51], v81
    ds_add_f64 v90, v[48:49] offset:42640
    ds_add_f64 v90, v[50:51] offset:42648
    v_cvt_f64_f32 v[56:57], v82
    v_cvt_f64_f32 v[58:59], v83
    ds_add_f64 v91, v[56:57] offset:42640
    ds_add_f64 v91, v[58:59] offset:42648
    v_mov_b32 v89, 1024
    v_add_f32 v120, v120, v121
    v_cmp_nge_f32 vcc, 0x7d800000, v120
    ds_read_b32 v89, v89
    s_cbranch_vccnz K2_BIG
K2_BIGB:
    s_cmp_ge_u32 s21, 8
    s_cbranch_scc1 K2_NOU
    v_xor_b32 v84, v5, v6
    v_lshlrev_b32 v84, 4, v84
    v_lshl_or_b32 v84, v6, 8, v84
    v_add_u32 v84, 115456, v84
    v_xor_b32 v85, 64, v84
    v_xor_b32 v86, 0x80, v84
    v_xor_b32 v87, 0xc0, v84
    ds_read_b128 v[32:35], v84 offset:0
    ds_read_b128 v[48:51], v84 offset:4096
    ds_read_b128 v[64:67], v84 offset:8192
    ds_read_b128 v[36:39], v85 offset:0
    ds_read_b128 v[52:55], v85 offset:4096
    ds_read_b128 v[68:71], v85 offset:8192
    ds_read_b128 v[40:43], v86 offset:0
    ds_read_b128 v[56:59], v86 offset:4096
    ds_read_b128 v[72:75], v86 offset:8192
    ds_read_b128 v[44:47], v87 offset:0
    ds_read_b128 v[60:63], v87 offset:4096
    ds_read_b128 v[76:79], v87 offset:8192
    v_mul_u32_u24 v124, 288, v6
    v_lshl_add_u32 v124, v5, 4, v124
    v_add_u32 v124, 127744, v124
    v_mul_u32_u24 v90, 272, v6
    v_lshl_add_u32 v90, v5, 3, v90
    s_lshl_b32 s36, s21, 5
    s_add_u32 s36, s36, 10240
    v_add_u32 v90, s36, v90
    v_lshrrev_b32 v88, 4, v0
    v_mul_u32_u24 v91, 272, v88
    v_lshl_add_u32 v91, v6, 4, v91
    v_lshlrev_b32 v88, 16, v88
    v_lshl_or_b32 v88, v6, 4, v88
    s_lshl_b32 s36, s20, 8
    v_add_u32 v88, s36, v88
    v_add_u32 v125, 0x200000, v88
    s_waitcnt vmcnt(4)
    s_waitcnt lgkmcnt(11)
    v_mfma_f32_16x16x32_bf16 v[108:111], v[16:19], v[32:35], 0
    s_waitcnt lgkmcnt(10)
    v_mfma_f32_16x16x32_bf16 v[112:115], v[16:19], v[48:51], 0
    s_waitcnt lgkmcnt(9)
    v_mfma_f32_16x16x32_bf16 v[116:119], v[16:19], v[64:67], 0
    s_waitcnt lgkmcnt(8)
    v_mfma_f32_16x16x32_bf16 v[108:111], v[20:23], v[36:39], v[108:111]
    s_waitcnt lgkmcnt(7)
    v_mfma_f32_16x16x32_bf16 v[112:115], v[20:23], v[52:55], v[112:115]
    s_waitcnt lgkmcnt(6)
    v_mfma_f32_16x16x32_bf16 v[116:119], v[20:23], v[68:71], v[116:119]
    s_waitcnt lgkmcnt(5)
    v_mfma_f32_16x16x32_bf16 v[108:111], v[24:27], v[40:43], v[108:111]
    s_waitcnt lgkmcnt(4)
    v_mfma_f32_16x16x32_bf16 v[112:115], v[24:27], v[56:59], v[112:115]
    s_waitcnt lgkmcnt(3)
    v_mfma_f32_16x16x32_bf16 v[116:119], v[24:27], v[72:75], v[116:119]
    s_waitcnt lgkmcnt(2)
    v_mfma_f32_16x16x32_bf16 v[108:111], v[28:31], v[44:47], v[108:111]
    s_waitcnt lgkmcnt(1)
    v_mfma_f32_16x16x32_bf16 v[112:115], v[28:31], v[60:63], v[112:115]
    s_waitcnt lgkmcnt(0)
    v_mfma_f32_16x16x32_bf16 v[116:119], v[28:31], v[76:79], v[116:119]
    s_cmp_lt_u32 s21, 6
    s_cbranch_scc1 K2_NOCA
K2_NOU:
    v_cvt_f32_u32 v84, v126
    s_lshl_b32 s36, s21, 2
    s_sub_u32 s36, s36, 24
    v_mul_f32 v84, 0xbe800000, v84
    s_mul_i32 s37, s36, 1040
    s_add_u32 s37, s37, 28672
    v_add_u32 v120, s37, v7
    s_mul_i32 s37, s36, 288
    s_add_u32 s37, s37, 127744
    v_lshl_add_u32 v121, v1, 2, s37
    v_readlane_b32 s60, v84, s36
    s_add_u32 s36, s36, 1
    v_readlane_b32 s62, v84, s36
    s_add_u32 s36, s36, 1
    v_readlane_b32 s64, v84, s36
    s_add_u32 s36, s36, 1
    v_readlane_b32 s66, v84, s36
K2_NOCA:
    s_waitcnt lgkmcnt(0)
    v_readfirstlane_b32 s57, v89
    s_barrier
    s_cmp_lg_u32 s57, 0
    s_cbranch_scc1 K2_NEXT
    v_mov_b32 v123, 1028
    ds_read_b32 v123, v123
    s_cmp_lt_u32 s21, 6
    s_cbranch_scc1 K2_NOCV
    ds_read_b128 v[16:19], v120 offset:42640
    ds_read_b64 v[8:9], v120 offset:8
    ds_read_b128 v[20:23], v120 offset:43680
    ds_read_b64 v[10:11], v120 offset:1048
    ds_read_b128 v[24:27], v120 offset:44720
    ds_read_b64 v[12:13], v120 offset:2088
    ds_read_b128 v[28:31], v120 offset:45760
    ds_read_b64 v[14:15], v120 offset:3128
    s_waitcnt lgkmcnt(6)
    v_cvt_f32_f64 v32, v[16:17]
    v_cvt_f32_f64 v33, v[18:19]
    v_pk_mul_f32 v[8:9], v[8:9], s[60:61] op_sel_hi:[1,0]
    v_pk_fma_f32 v[32:33], v[32:33], s[70:71], v[8:9] op_sel_hi:[1,0,1]
    v_cvt_pk_bf16_f32 v40, v32, v33
    ds_write_b32 v121, v40 offset:0
    s_waitcnt lgkmcnt(5)
    v_cvt_f32_f64 v34, v[20:21]
    v_cvt_f32_f64 v35, v[22:23]
    v_pk_mul_f32 v[10:11], v[10:11], s[62:63] op_sel_hi:[1,0]
    v_pk_fma_f32 v[34:35], v[34:35], s[70:71], v[10:11] op_sel_hi:[1,0,1]
    v_cvt_pk_bf16_f32 v41, v34, v35
    ds_write_b32 v121, v41 offset:288
    s_waitcnt lgkmcnt(4)
    v_cvt_f32_f64 v36, v[24:25]
    v_cvt_f32_f64 v37, v[26:27]
    v_pk_mul_f32 v[12:13], v[12:13], s[64:65] op_sel_hi:[1,0]
    v_pk_fma_f32 v[36:37], v[36:37], s[70:71], v[12:13] op_sel_hi:[1,0,1]
    v_cvt_pk_bf16_f32 v42, v36, v37
    ds_write_b32 v121, v42 offset:576
    s_waitcnt lgkmcnt(3)
    v_cvt_f32_f64 v38, v[28:29]
    v_cvt_f32_f64 v39, v[30:31]
    v_pk_mul_f32 v[14:15], v[14:15], s[66:67] op_sel_hi:[1,0]
    v_pk_fma_f32 v[38:39], v[38:39], s[70:71], v[14:15] op_sel_hi:[1,0,1]
    v_cvt_pk_bf16_f32 v43, v38, v39
    ds_write_b32 v121, v43 offset:864
K2_NOCV:
    s_waitcnt lgkmcnt(0)
    v_readfirstlane_b32 s36, v123
    s_barrier
    s_cmp_lg_u32 s36, 0
    s_cbranch_scc1 K2_RESTART
    s_cmp_ge_u32 s21, 8
    s_cbranch_scc1 K2_FIN
    ds_read_b128 v[16:19], v124 offset:0
    ds_read_b128 v[20:23], v124 offset:64
    ds_read_b128 v[24:27], v124 offset:128
    ds_read_b128 v[28:31], v124 offset:192
    ds_read_b128 v[32:35], v124 offset:4608
    ds_read_b128 v[36:39], v124 offset:4672
    ds_read_b128 v[40:43], v124 offset:4736
    ds_read_b128 v[44:47], v124 offset:4800
    ds_read_b128 v[48:51], v124 offset:9216
    ds_read_b128 v[52:55], v124 offset:9280
    ds_read_b128 v[56:59], v124 offset:9344
    ds_read_b128 v[60:63], v124 offset:9408
    s_waitcnt vmcnt(0)
    s_waitcnt lgkmcnt(11)
    v_mfma_f32_16x16x32_bf16 v[108:111], v[92:95], v[16:19], v[108:111]
    s_waitcnt lgkmcnt(10)
    v_mfma_f32_16x16x32_bf16 v[108:111], v[96:99], v[20:23], v[108:111]
    s_waitcnt lgkmcnt(9)
    v_mfma_f32_16x16x32_bf16 v[108:111], v[100:103], v[24:27], v[108:111]
    s_waitcnt lgkmcnt(8)
    v_mfma_f32_16x16x32_bf16 v[108:111], v[104:107], v[28:31], v[108:111]
    s_waitcnt lgkmcnt(7)
    v_mfma_f32_16x16x32_bf16 v[112:115], v[92:95], v[32:35], v[112:115]
    s_waitcnt lgkmcnt(6)
    v_mfma_f32_16x16x32_bf16 v[112:115], v[96:99], v[36:39], v[112:115]
    s_waitcnt lgkmcnt(5)
    v_mfma_f32_16x16x32_bf16 v[112:115], v[100:103], v[40:43], v[112:115]
    s_waitcnt lgkmcnt(4)
    v_mfma_f32_16x16x32_bf16 v[112:115], v[104:107], v[44:47], v[112:115]
    v_pk_mul_f32 v[76:77], v[108:109], s[72:73] op_sel_hi:[1,0]
    v_pk_mul_f32 v[78:79], v[110:111], s[72:73] op_sel_hi:[1,0]
    s_waitcnt lgkmcnt(0)
    v_mfma_f32_16x16x32_bf16 v[116:119], v[92:95], v[48:51], v[116:119]
    v_exp_f32 v76, v76
    v_mfma_f32_16x16x32_bf16 v[116:119], v[96:99], v[52:55], v[116:119]
    v_exp_f32 v77, v77
    v_mfma_f32_16x16x32_bf16 v[116:119], v[100:103], v[56:59], v[116:119]
    v_exp_f32 v78, v78
    v_mfma_f32_16x16x32_bf16 v[116:119], v[104:107], v[60:63], v[116:119]
    v_exp_f32 v79, v79
    s_nop 0
    v_pk_mul_f32 v[80:81], v[112:113], s[72:73] op_sel_hi:[1,0]
    v_pk_mul_f32 v[82:83], v[114:115], s[72:73] op_sel_hi:[1,0]
    v_exp_f32 v80, v80
    v_exp_f32 v81, v81
    v_exp_f32 v82, v82
    v_exp_f32 v83, v83
    v_pk_add_f32 v[76:77], v[76:77], 1.0 op_sel_hi:[1,0]
    v_pk_add_f32 v[78:79], v[78:79], 1.0 op_sel_hi:[1,0]
    v_rcp_f32 v76, v76
    v_rcp_f32 v77, v77
    v_rcp_f32 v78, v78
    v_rcp_f32 v79, v79
    v_pk_mul_f32 v[84:85], v[116:117], s[72:73] op_sel_hi:[1,0]
    v_pk_mul_f32 v[86:87], v[118:119], s[72:73] op_sel_hi:[1,0]
    v_exp_f32 v84, v84
    v_exp_f32 v85, v85
    v_exp_f32 v86, v86
    v_exp_f32 v87, v87
    v_pk_mul_f32 v[76:77], v[76:77], v[108:109]
    v_pk_mul_f32 v[78:79], v[78:79], v[110:111]
    v_cvt_pk_bf16_f32 v8, v76, v77
    v_cvt_pk_bf16_f32 v9, v78, v79
    ds_write_b64 v90, v[8:9] offset:0
    v_pk_add_f32 v[80:81], v[80:81], 1.0 op_sel_hi:[1,0]
    v_pk_add_f32 v[82:83], v[82:83], 1.0 op_sel_hi:[1,0]
    v_rcp_f32 v80, v80
    v_rcp_f32 v81, v81
    v_rcp_f32 v82, v82
    v_rcp_f32 v83, v83
    v_pk_add_f32 v[84:85], v[84:85], 1.0 op_sel_hi:[1,0]
    v_pk_add_f32 v[86:87], v[86:87], 1.0 op_sel_hi:[1,0]
    v_pk_mul_f32 v[80:81], v[80:81], v[112:113]
    v_pk_mul_f32 v[82:83], v[82:83], v[114:115]
    v_cvt_pk_bf16_f32 v10, v80, v81
    v_cvt_pk_bf16_f32 v11, v82, v83
    ds_write_b64 v90, v[10:11] offset:4352
    v_rcp_f32 v84, v84
    v_rcp_f32 v85, v85
    v_rcp_f32 v86, v86
    v_rcp_f32 v87, v87
    s_nop 0
    v_pk_mul_f32 v[84:85], v[84:85], v[116:117]
    v_pk_mul_f32 v[86:87], v[86:87], v[118:119]
    v_cvt_pk_bf16_f32 v12, v84, v85
    v_cvt_pk_bf16_f32 v13, v86, v87
    ds_write_b64 v90, v[12:13] offset:8704
    s_cmp_ge_u32 s21, 2
    s_waitcnt lgkmcnt(0)
    s_barrier
    ds_read_b128 v[16:19], v91 offset:10240
    s_cbranch_scc1 K2_O1
    ds_read_b128 v[20:23], v91 offset:18944
    s_waitcnt lgkmcnt(0)
    buffer_store_dwordx4 v[20:23], v125, s[16:19], 0 offen
K2_O1:
    s_waitcnt lgkmcnt(0)
    buffer_store_dwordx4 v[16:19], v88, s[16:19], 0 offen
K2_FIN:
K2_END:
    s_endpgm
K2_EV0_0:
    s_bfe_i32 exec_lo, s28, 0x10000
    s_bfe_i32 exec_hi, s29, 0x10000
    s_cbranch_execz K2_EQ0_0
    v_rcp_f32 v52, v76
    v_rcp_f32 v53, v77
    v_add_u32 v90, 1040, v90
    v_pk_mul_f32 v[80:81], v[80:81], v[52:53]
    v_pk_fma_f32 v[120:121], v[80:81], v[80:81], v[120:121]
    v_cvt_f64_f32 v[48:49], v80
    v_cvt_f64_f32 v[50:51], v81
    ds_add_f64 v90, v[48:49] offset:41600
    ds_add_f64 v90, v[50:51] offset:41608
    v_mov_b64 v[80:81], 0
K2_EQ0_0:
    s_bfe_i32 exec_lo, s28, 0x10001
    s_bfe_i32 exec_hi, s29, 0x10001
    ds_read_b64 v[72:73], v90 offset:1040
    s_mov_b64 exec, -1
    s_branch K2_EB0_0
K2_EV0_1:
    s_bfe_i32 exec_lo, s30, 0x10000
    s_bfe_i32 exec_hi, s31, 0x10000
    s_cbranch_execz K2_EQ0_1
    v_rcp_f32 v60, v78
    v_rcp_f32 v61, v79
    v_add_u32 v91, 1040, v91
    v_pk_mul_f32 v[82:83], v[82:83], v[60:61]
    v_pk_fma_f32 v[120:121], v[82:83], v[82:83], v[120:121]
    v_cvt_f64_f32 v[56:57], v82
    v_cvt_f64_f32 v[58:59], v83
    ds_add_f64 v91, v[56:57] offset:41600
    ds_add_f64 v91, v[58:59] offset:41608
    v_mov_b64 v[82:83], 0
K2_EQ0_1:
    s_bfe_i32 exec_lo, s30, 0x10001
    s_bfe_i32 exec_hi, s31, 0x10001
    ds_read_b64 v[74:75], v91 offset:1040
    s_mov_b64 exec, -1
    s_branch K2_EB0_1
K2_EV1_0:
    s_bfe_i32 exec_lo, s28, 0x10001
    s_bfe_i32 exec_hi, s29, 0x10001
    s_cbranch_execz K2_EQ1_0
    v_rcp_f32 v52, v76
    v_rcp_f32 v53, v77
    v_add_u32 v90, 1040, v90
    v_pk_mul_f32 v[80:81], v[80:81], v[52:53]
    v_pk_fma_f32 v[120:121], v[80:81], v[80:81], v[120:121]
    v_cvt_f64_f32 v[48:49], v80
    v_cvt_f64_f32 v[50:51], v81
    ds_add_f64 v90, v[48:49] offset:41600
    ds_add_f64 v90, v[50:51] offset:41608
    v_mov_b64 v[80:81], 0
K2_EQ1_0:
    s_bfe_i32 exec_lo, s28, 0x10002
    s_bfe_i32 exec_hi, s29, 0x10002
    ds_read_b64 v[72:73], v90 offset:1040
    s_mov_b64 exec, -1
    s_branch K2_EB1_0
K2_EV1_1:
    s_bfe_i32 exec_lo, s30, 0x10001
    s_bfe_i32 exec_hi, s31, 0x10001
    s_cbranch_execz K2_EQ1_1
    v_rcp_f32 v60, v78
    v_rcp_f32 v61, v79
    v_add_u32 v91, 1040, v91
    v_pk_mul_f32 v[82:83], v[82:83], v[60:61]
    v_pk_fma_f32 v[120:121], v[82:83], v[82:83], v[120:121]
    v_cvt_f64_f32 v[56:57], v82
    v_cvt_f64_f32 v[58:59], v83
    ds_add_f64 v91, v[56:57] offset:41600
    ds_add_f64 v91, v[58:59] offset:41608
    v_mov_b64 v[82:83], 0
K2_EQ1_1:
    s_bfe_i32 exec_lo, s30, 0x10002
    s_bfe_i32 exec_hi, s31, 0x10002
    ds_read_b64 v[74:75], v91 offset:1040
    s_mov_b64 exec, -1
    s_branch K2_EB1_1
K2_EV2_0:
    s_bfe_i32 exec_lo, s28, 0x10002
    s_bfe_i32 exec_hi, s29, 0x10002
    s_cbranch_execz K2_EQ2_0
    v_rcp_f32 v52, v76
    v_rcp_f32 v53, v77
    v_add_u32 v90, 1040, v90
    v_pk_mul_f32 v[80:81], v[80:81], v[52:53]
    v_pk_fma_f32 v[120:121], v[80:81], v[80:81], v[120:121]
    v_cvt_f64_f32 v[48:49], v80
    v_cvt_f64_f32 v[50:51], v81
    ds_add_f64 v90, v[48:49] offset:41600
    ds_add_f64 v90, v[50:51] offset:41608
    v_mov_b64 v[80:81], 0
K2_EQ2_0:
    s_bfe_i32 exec_lo, s28, 0x10003
    s_bfe_i32 exec_hi, s29, 0x10003
    ds_read_b64 v[72:73], v90 offset:1040
    s_mov_b64 exec, -1
    s_branch K2_EB2_0
K2_EV2_1:
    s_bfe_i32 exec_lo, s30, 0x10002
    s_bfe_i32 exec_hi, s31, 0x10002
    s_cbranch_execz K2_EQ2_1
    v_rcp_f32 v60, v78
    v_rcp_f32 v61, v79
    v_add_u32 v91, 1040, v91
    v_pk_mul_f32 v[82:83], v[82:83], v[60:61]
    v_pk_fma_f32 v[120:121], v[82:83], v[82:83], v[120:121]
    v_cvt_f64_f32 v[56:57], v82
    v_cvt_f64_f32 v[58:59], v83
    ds_add_f64 v91, v[56:57] offset:41600
    ds_add_f64 v91, v[58:59] offset:41608
    v_mov_b64 v[82:83], 0
K2_EQ2_1:
    s_bfe_i32 exec_lo, s30, 0x10003
    s_bfe_i32 exec_hi, s31, 0x10003
    ds_read_b64 v[74:75], v91 offset:1040
    s_mov_b64 exec, -1
    s_branch K2_EB2_1
K2_EV3_0:
    s_bfe_i32 exec_lo, s28, 0x10003
    s_bfe_i32 exec_hi, s29, 0x10003
    s_cbranch_execz K2_EQ3_0
    v_rcp_f32 v52, v76
    v_rcp_f32 v53, v77
    v_add_u32 v90, 1040, v90
    v_pk_mul_f32 v[80:81], v[80:81], v[52:53]
    v_pk_fma_f32 v[120:121], v[80:81], v[80:81], v[120:121]
    v_cvt_f64_f32 v[48:49], v80
    v_cvt_f64_f32 v[50:51], v81
    ds_add_f64 v90, v[48:49] offset:41600
    ds_add_f64 v90, v[50:51] offset:41608
    v_mov_b64 v[80:81], 0
K2_EQ3_0:
    s_bfe_i32 exec_lo, s28, 0x10004
    s_bfe_i32 exec_hi, s29, 0x10004
    ds_read_b64 v[72:73], v90 offset:1040
    s_mov_b64 exec, -1
    s_branch K2_EB3_0
K2_EV3_1:
    s_bfe_i32 exec_lo, s30, 0x10003
    s_bfe_i32 exec_hi, s31, 0x10003
    s_cbranch_execz K2_EQ3_1
    v_rcp_f32 v60, v78
    v_rcp_f32 v61, v79
    v_add_u32 v91, 1040, v91
    v_pk_mul_f32 v[82:83], v[82:83], v[60:61]
    v_pk_fma_f32 v[120:121], v[82:83], v[82:83], v[120:121]
    v_cvt_f64_f32 v[56:57], v82
    v_cvt_f64_f32 v[58:59], v83
    ds_add_f64 v91, v[56:57] offset:41600
    ds_add_f64 v91, v[58:59] offset:41608
    v_mov_b64 v[82:83], 0
K2_EQ3_1:
    s_bfe_i32 exec_lo, s30, 0x10004
    s_bfe_i32 exec_hi, s31, 0x10004
    ds_read_b64 v[74:75], v91 offset:1040
    s_mov_b64 exec, -1
    s_branch K2_EB3_1
K2_EV4_0:
    s_bfe_i32 exec_lo, s28, 0x10004
    s_bfe_i32 exec_hi, s29, 0x10004
    s_cbranch_execz K2_EQ4_0
    v_rcp_f32 v52, v76
    v_rcp_f32 v53, v77
    v_add_u32 v90, 1040, v90
    v_pk_mul_f32 v[80:81], v[80:81], v[52:53]
    v_pk_fma_f32 v[120:121], v[80:81], v[80:81], v[120:121]
    v_cvt_f64_f32 v[48:49], v80
    v_cvt_f64_f32 v[50:51], v81
    ds_add_f64 v90, v[48:49] offset:41600
    ds_add_f64 v90, v[50:51] offset:41608
    v_mov_b64 v[80:81], 0
K2_EQ4_0:
    s_bfe_i32 exec_lo, s28, 0x10005
    s_bfe_i32 exec_hi, s29, 0x10005
    ds_read_b64 v[72:73], v90 offset:1040
    s_mov_b64 exec, -1
    s_branch K2_EB4_0
K2_EV4_1:
    s_bfe_i32 exec_lo, s30, 0x10004
    s_bfe_i32 exec_hi, s31, 0x10004
    s_cbranch_execz K2_EQ4_1
    v_rcp_f32 v60, v78
    v_rcp_f32 v61, v79
    v_add_u32 v91, 1040, v91
    v_pk_mul_f32 v[82:83], v[82:83], v[60:61]
    v_pk_fma_f32 v[120:121], v[82:83], v[82:83], v[120:121]
    v_cvt_f64_f32 v[56:57], v82
    v_cvt_f64_f32 v[58:59], v83
    ds_add_f64 v91, v[56:57] offset:41600
    ds_add_f64 v91, v[58:59] offset:41608
    v_mov_b64 v[82:83], 0
K2_EQ4_1:
    s_bfe_i32 exec_lo, s30, 0x10005
    s_bfe_i32 exec_hi, s31, 0x10005
    ds_read_b64 v[74:75], v91 offset:1040
    s_mov_b64 exec, -1
    s_branch K2_EB4_1
K2_EV5_0:
    s_bfe_i32 exec_lo, s28, 0x10005
    s_bfe_i32 exec_hi, s29, 0x10005
    s_cbranch_execz K2_EQ5_0
    v_rcp_f32 v52, v76
    v_rcp_f32 v53, v77
    v_add_u32 v90, 1040, v90
    v_pk_mul_f32 v[80:81], v[80:81], v[52:53]
    v_pk_fma_f32 v[120:121], v[80:81], v[80:81], v[120:121]
    v_cvt_f64_f32 v[48:49], v80
    v_cvt_f64_f32 v[50:51], v81
    ds_add_f64 v90, v[48:49] offset:41600
    ds_add_f64 v90, v[50:51] offset:41608
    v_mov_b64 v[80:81], 0
K2_EQ5_0:
    s_bfe_i32 exec_lo, s28, 0x10006
    s_bfe_i32 exec_hi, s29, 0x10006
    ds_read_b64 v[72:73], v90 offset:1040
    s_mov_b64 exec, -1
    s_branch K2_EB5_0
K2_EV5_1:
    s_bfe_i32 exec_lo, s30, 0x10005
    s_bfe_i32 exec_hi, s31, 0x10005
    s_cbranch_execz K2_EQ5_1
    v_rcp_f32 v60, v78
    v_rcp_f32 v61, v79
    v_add_u32 v91, 1040, v91
    v_pk_mul_f32 v[82:83], v[82:83], v[60:61]
    v_pk_fma_f32 v[120:121], v[82:83], v[82:83], v[120:121]
    v_cvt_f64_f32 v[56:57], v82
    v_cvt_f64_f32 v[58:59], v83
    ds_add_f64 v91, v[56:57] offset:41600
    ds_add_f64 v91, v[58:59] offset:41608
    v_mov_b64 v[82:83], 0
K2_EQ5_1:
    s_bfe_i32 exec_lo, s30, 0x10006
    s_bfe_i32 exec_hi, s31, 0x10006
    ds_read_b64 v[74:75], v91 offset:1040
    s_mov_b64 exec, -1
    s_branch K2_EB5_1
K2_EV6_0:
    s_bfe_i32 exec_lo, s28, 0x10006
    s_bfe_i32 exec_hi, s29, 0x10006
    s_cbranch_execz K2_EQ6_0
    v_rcp_f32 v52, v76
    v_rcp_f32 v53, v77
    v_add_u32 v90, 1040, v90
    v_pk_mul_f32 v[80:81], v[80:81], v[52:53]
    v_pk_fma_f32 v[120:121], v[80:81], v[80:81], v[120:121]
    v_cvt_f64_f32 v[48:49], v80
    v_cvt_f64_f32 v[50:51], v81
    ds_add_f64 v90, v[48:49] offset:41600
    ds_add_f64 v90, v[50:51] offset:41608
    v_mov_b64 v[80:81], 0
K2_EQ6_0:
    s_bfe_i32 exec_lo, s28, 0x10007
    s_bfe_i32 exec_hi, s29, 0x10007
    ds_read_b64 v[72:73], v90 offset:1040
    s_mov_b64 exec, -1
    s_branch K2_EB6_0
K2_EV6_1:
    s_bfe_i32 exec_lo, s30, 0x10006
    s_bfe_i32 exec_hi, s31, 0x10006
    s_cbranch_execz K2_EQ6_1
    v_rcp_f32 v60, v78
    v_rcp_f32 v61, v79
    v_add_u32 v91, 1040, v91
    v_pk_mul_f32 v[82:83], v[82:83], v[60:61]
    v_pk_fma_f32 v[120:121], v[82:83], v[82:83], v[120:121]
    v_cvt_f64_f32 v[56:57], v82
    v_cvt_f64_f32 v[58:59], v83
    ds_add_f64 v91, v[56:57] offset:41600
    ds_add_f64 v91, v[58:59] offset:41608
    v_mov_b64 v[82:83], 0
K2_EQ6_1:
    s_bfe_i32 exec_lo, s30, 0x10007
    s_bfe_i32 exec_hi, s31, 0x10007
    ds_read_b64 v[74:75], v91 offset:1040
    s_mov_b64 exec, -1
    s_branch K2_EB6_1
K2_EV7_0:
    s_bfe_i32 exec_lo, s28, 0x10007
    s_bfe_i32 exec_hi, s29, 0x10007
    s_cbranch_execz K2_EQ7_0
    v_rcp_f32 v52, v76
    v_rcp_f32 v53, v77
    v_add_u32 v90, 1040, v90
    v_pk_mul_f32 v[80:81], v[80:81], v[52:53]
    v_pk_fma_f32 v[120:121], v[80:81], v[80:81], v[120:121]
    v_cvt_f64_f32 v[48:49], v80
    v_cvt_f64_f32 v[50:51], v81
    ds_add_f64 v90, v[48:49] offset:41600
    ds_add_f64 v90, v[50:51] offset:41608
    v_mov_b64 v[80:81], 0
K2_EQ7_0:
    s_bfe_i32 exec_lo, s28, 0x10008
    s_bfe_i32 exec_hi, s29, 0x10008
    ds_read_b64 v[72:73], v90 offset:1040
    s_mov_b64 exec, -1
    s_branch K2_EB7_0
K2_EV7_1:
    s_bfe_i32 exec_lo, s30, 0x10007
    s_bfe_i32 exec_hi, s31, 0x10007
    s_cbranch_execz K2_EQ7_1
    v_rcp_f32 v60, v78
    v_rcp_f32 v61, v79
    v_add_u32 v91, 1040, v91
    v_pk_mul_f32 v[82:83], v[82:83], v[60:61]
    v_pk_fma_f32 v[120:121], v[82:83], v[82:83], v[120:121]
    v_cvt_f64_f32 v[56:57], v82
    v_cvt_f64_f32 v[58:59], v83
    ds_add_f64 v91, v[56:57] offset:41600
    ds_add_f64 v91, v[58:59] offset:41608
    v_mov_b64 v[82:83], 0
K2_EQ7_1:
    s_bfe_i32 exec_lo, s30, 0x10008
    s_bfe_i32 exec_hi, s31, 0x10008
    ds_read_b64 v[74:75], v91 offset:1040
    s_mov_b64 exec, -1
    s_branch K2_EB7_1
K2_EV8_0:
    s_bfe_i32 exec_lo, s28, 0x10008
    s_bfe_i32 exec_hi, s29, 0x10008
    s_cbranch_execz K2_EQ8_0
    v_rcp_f32 v52, v76
    v_rcp_f32 v53, v77
    v_add_u32 v90, 1040, v90
    v_pk_mul_f32 v[80:81], v[80:81], v[52:53]
    v_pk_fma_f32 v[120:121], v[80:81], v[80:81], v[120:121]
    v_cvt_f64_f32 v[48:49], v80
    v_cvt_f64_f32 v[50:51], v81
    ds_add_f64 v90, v[48:49] offset:41600
    ds_add_f64 v90, v[50:51] offset:41608
    v_mov_b64 v[80:81], 0
K2_EQ8_0:
    s_bfe_i32 exec_lo, s28, 0x10009
    s_bfe_i32 exec_hi, s29, 0x10009
    ds_read_b64 v[72:73], v90 offset:1040
    s_mov_b64 exec, -1
    s_branch K2_EB8_0
K2_EV8_1:
    s_bfe_i32 exec_lo, s30, 0x10008
    s_bfe_i32 exec_hi, s31, 0x10008
    s_cbranch_execz K2_EQ8_1
    v_rcp_f32 v60, v78
    v_rcp_f32 v61, v79
    v_add_u32 v91, 1040, v91
    v_pk_mul_f32 v[82:83], v[82:83], v[60:61]
    v_pk_fma_f32 v[120:121], v[82:83], v[82:83], v[120:121]
    v_cvt_f64_f32 v[56:57], v82
    v_cvt_f64_f32 v[58:59], v83
    ds_add_f64 v91, v[56:57] offset:41600
    ds_add_f64 v91, v[58:59] offset:41608
    v_mov_b64 v[82:83], 0
K2_EQ8_1:
    s_bfe_i32 exec_lo, s30, 0x10009
    s_bfe_i32 exec_hi, s31, 0x10009
    ds_read_b64 v[74:75], v91 offset:1040
    s_mov_b64 exec, -1
    s_branch K2_EB8_1
K2_EV9_0:
    s_bfe_i32 exec_lo, s28, 0x10009
    s_bfe_i32 exec_hi, s29, 0x10009
    s_cbranch_execz K2_EQ9_0
    v_rcp_f32 v52, v76
    v_rcp_f32 v53, v77
    v_add_u32 v90, 1040, v90
    v_pk_mul_f32 v[80:81], v[80:81], v[52:53]
    v_pk_fma_f32 v[120:121], v[80:81], v[80:81], v[120:121]
    v_cvt_f64_f32 v[48:49], v80
    v_cvt_f64_f32 v[50:51], v81
    ds_add_f64 v90, v[48:49] offset:41600
    ds_add_f64 v90, v[50:51] offset:41608
    v_mov_b64 v[80:81], 0
K2_EQ9_0:
    s_bfe_i32 exec_lo, s28, 0x1000a
    s_bfe_i32 exec_hi, s29, 0x1000a
    ds_read_b64 v[72:73], v90 offset:1040
    s_mov_b64 exec, -1
    s_branch K2_EB9_0
K2_EV9_1:
    s_bfe_i32 exec_lo, s30, 0x10009
    s_bfe_i32 exec_hi, s31, 0x10009
    s_cbranch_execz K2_EQ9_1
    v_rcp_f32 v60, v78
    v_rcp_f32 v61, v79
    v_add_u32 v91, 1040, v91
    v_pk_mul_f32 v[82:83], v[82:83], v[60:61]
    v_pk_fma_f32 v[120:121], v[82:83], v[82:83], v[120:121]
    v_cvt_f64_f32 v[56:57], v82
    v_cvt_f64_f32 v[58:59], v83
    ds_add_f64 v91, v[56:57] offset:41600
    ds_add_f64 v91, v[58:59] offset:41608
    v_mov_b64 v[82:83], 0
K2_EQ9_1:
    s_bfe_i32 exec_lo, s30, 0x1000a
    s_bfe_i32 exec_hi, s31, 0x1000a
    ds_read_b64 v[74:75], v91 offset:1040
    s_mov_b64 exec, -1
    s_branch K2_EB9_1
K2_EV10_0:
    s_bfe_i32 exec_lo, s28, 0x1000a
    s_bfe_i32 exec_hi, s29, 0x1000a
    s_cbranch_execz K2_EQ10_0
    v_rcp_f32 v52, v76
    v_rcp_f32 v53, v77
    v_add_u32 v90, 1040, v90
    v_pk_mul_f32 v[80:81], v[80:81], v[52:53]
    v_pk_fma_f32 v[120:121], v[80:81], v[80:81], v[120:121]
    v_cvt_f64_f32 v[48:49], v80
    v_cvt_f64_f32 v[50:51], v81
    ds_add_f64 v90, v[48:49] offset:41600
    ds_add_f64 v90, v[50:51] offset:41608
    v_mov_b64 v[80:81], 0
K2_EQ10_0:
    s_bfe_i32 exec_lo, s28, 0x1000b
    s_bfe_i32 exec_hi, s29, 0x1000b
    ds_read_b64 v[72:73], v90 offset:1040
    s_mov_b64 exec, -1
    s_branch K2_EB10_0
K2_EV10_1:
    s_bfe_i32 exec_lo, s30, 0x1000a
    s_bfe_i32 exec_hi, s31, 0x1000a
    s_cbranch_execz K2_EQ10_1
    v_rcp_f32 v60, v78
    v_rcp_f32 v61, v79
    v_add_u32 v91, 1040, v91
    v_pk_mul_f32 v[82:83], v[82:83], v[60:61]
    v_pk_fma_f32 v[120:121], v[82:83], v[82:83], v[120:121]
    v_cvt_f64_f32 v[56:57], v82
    v_cvt_f64_f32 v[58:59], v83
    ds_add_f64 v91, v[56:57] offset:41600
    ds_add_f64 v91, v[58:59] offset:41608
    v_mov_b64 v[82:83], 0
K2_EQ10_1:
    s_bfe_i32 exec_lo, s30, 0x1000b
    s_bfe_i32 exec_hi, s31, 0x1000b
    ds_read_b64 v[74:75], v91 offset:1040
    s_mov_b64 exec, -1
    s_branch K2_EB10_1
K2_EV11_0:
    s_bfe_i32 exec_lo, s28, 0x1000b
    s_bfe_i32 exec_hi, s29, 0x1000b
    s_cbranch_execz K2_EQ11_0
    v_rcp_f32 v52, v76
    v_rcp_f32 v53, v77
    v_add_u32 v90, 1040, v90
    v_pk_mul_f32 v[80:81], v[80:81], v[52:53]
    v_pk_fma_f32 v[120:121], v[80:81], v[80:81], v[120:121]
    v_cvt_f64_f32 v[48:49], v80
    v_cvt_f64_f32 v[50:51], v81
    ds_add_f64 v90, v[48:49] offset:41600
    ds_add_f64 v90, v[50:51] offset:41608
    v_mov_b64 v[80:81], 0
K2_EQ11_0:
    s_bfe_i32 exec_lo, s28, 0x1000c
    s_bfe_i32 exec_hi, s29, 0x1000c
    ds_read_b64 v[72:73], v90 offset:1040
    s_mov_b64 exec, -1
    s_branch K2_EB11_0
K2_EV11_1:
    s_bfe_i32 exec_lo, s30, 0x1000b
    s_bfe_i32 exec_hi, s31, 0x1000b
    s_cbranch_execz K2_EQ11_1
    v_rcp_f32 v60, v78
    v_rcp_f32 v61, v79
    v_add_u32 v91, 1040, v91
    v_pk_mul_f32 v[82:83], v[82:83], v[60:61]
    v_pk_fma_f32 v[120:121], v[82:83], v[82:83], v[120:121]
    v_cvt_f64_f32 v[56:57], v82
    v_cvt_f64_f32 v[58:59], v83
    ds_add_f64 v91, v[56:57] offset:41600
    ds_add_f64 v91, v[58:59] offset:41608
    v_mov_b64 v[82:83], 0
K2_EQ11_1:
    s_bfe_i32 exec_lo, s30, 0x1000c
    s_bfe_i32 exec_hi, s31, 0x1000c
    ds_read_b64 v[74:75], v91 offset:1040
    s_mov_b64 exec, -1
    s_branch K2_EB11_1
K2_EV12_0:
    s_bfe_i32 exec_lo, s28, 0x1000c
    s_bfe_i32 exec_hi, s29, 0x1000c
    s_cbranch_execz K2_EQ12_0
    v_rcp_f32 v52, v76
    v_rcp_f32 v53, v77
    v_add_u32 v90, 1040, v90
    v_pk_mul_f32 v[80:81], v[80:81], v[52:53]
    v_pk_fma_f32 v[120:121], v[80:81], v[80:81], v[120:121]
    v_cvt_f64_f32 v[48:49], v80
    v_cvt_f64_f32 v[50:51], v81
    ds_add_f64 v90, v[48:49] offset:41600
    ds_add_f64 v90, v[50:51] offset:41608
    v_mov_b64 v[80:81], 0
K2_EQ12_0:
    s_bfe_i32 exec_lo, s28, 0x1000d
    s_bfe_i32 exec_hi, s29, 0x1000d
    ds_read_b64 v[72:73], v90 offset:1040
    s_mov_b64 exec, -1
    s_branch K2_EB12_0
K2_EV12_1:
    s_bfe_i32 exec_lo, s30, 0x1000c
    s_bfe_i32 exec_hi, s31, 0x1000c
    s_cbranch_execz K2_EQ12_1
    v_rcp_f32 v60, v78
    v_rcp_f32 v61, v79
    v_add_u32 v91, 1040, v91
    v_pk_mul_f32 v[82:83], v[82:83], v[60:61]
    v_pk_fma_f32 v[120:121], v[82:83], v[82:83], v[120:121]
    v_cvt_f64_f32 v[56:57], v82
    v_cvt_f64_f32 v[58:59], v83
    ds_add_f64 v91, v[56:57] offset:41600
    ds_add_f64 v91, v[58:59] offset:41608
    v_mov_b64 v[82:83], 0
K2_EQ12_1:
    s_bfe_i32 exec_lo, s30, 0x1000d
    s_bfe_i32 exec_hi, s31, 0x1000d
    ds_read_b64 v[74:75], v91 offset:1040
    s_mov_b64 exec, -1
    s_branch K2_EB12_1
K2_EV13_0:
    s_bfe_i32 exec_lo, s28, 0x1000d
    s_bfe_i32 exec_hi, s29, 0x1000d
    s_cbranch_execz K2_EQ13_0
    v_rcp_f32 v52, v76
    v_rcp_f32 v53, v77
    v_add_u32 v90, 1040, v90
    v_pk_mul_f32 v[80:81], v[80:81], v[52:53]
    v_pk_fma_f32 v[120:121], v[80:81], v[80:81], v[120:121]
    v_cvt_f64_f32 v[48:49], v80
    v_cvt_f64_f32 v[50:51], v81
    ds_add_f64 v90, v[48:49] offset:41600
    ds_add_f64 v90, v[50:51] offset:41608
    v_mov_b64 v[80:81], 0
K2_EQ13_0:
    s_bfe_i32 exec_lo, s28, 0x1000e
    s_bfe_i32 exec_hi, s29, 0x1000e
    ds_read_b64 v[72:73], v90 offset:1040
    s_mov_b64 exec, -1
    s_branch K2_EB13_0
K2_EV13_1:
    s_bfe_i32 exec_lo, s30, 0x1000d
    s_bfe_i32 exec_hi, s31, 0x1000d
    s_cbranch_execz K2_EQ13_1
    v_rcp_f32 v60, v78
    v_rcp_f32 v61, v79
    v_add_u32 v91, 1040, v91
    v_pk_mul_f32 v[82:83], v[82:83], v[60:61]
    v_pk_fma_f32 v[120:121], v[82:83], v[82:83], v[120:121]
    v_cvt_f64_f32 v[56:57], v82
    v_cvt_f64_f32 v[58:59], v83
    ds_add_f64 v91, v[56:57] offset:41600
    ds_add_f64 v91, v[58:59] offset:41608
    v_mov_b64 v[82:83], 0
K2_EQ13_1:
    s_bfe_i32 exec_lo, s30, 0x1000e
    s_bfe_i32 exec_hi, s31, 0x1000e
    ds_read_b64 v[74:75], v91 offset:1040
    s_mov_b64 exec, -1
    s_branch K2_EB13_1
K2_EV14_0:
    s_bfe_i32 exec_lo, s28, 0x1000e
    s_bfe_i32 exec_hi, s29, 0x1000e
    s_cbranch_execz K2_EQ14_0
    v_rcp_f32 v52, v76
    v_rcp_f32 v53, v77
    v_add_u32 v90, 1040, v90
    v_pk_mul_f32 v[80:81], v[80:81], v[52:53]
    v_pk_fma_f32 v[120:121], v[80:81], v[80:81], v[120:121]
    v_cvt_f64_f32 v[48:49], v80
    v_cvt_f64_f32 v[50:51], v81
    ds_add_f64 v90, v[48:49] offset:41600
    ds_add_f64 v90, v[50:51] offset:41608
    v_mov_b64 v[80:81], 0
K2_EQ14_0:
    s_mov_b64 exec, -1
    s_branch K2_EB14_0
K2_EV14_1:
    s_bfe_i32 exec_lo, s30, 0x1000e
    s_bfe_i32 exec_hi, s31, 0x1000e
    s_cbranch_execz K2_EQ14_1
    v_rcp_f32 v60, v78
    v_rcp_f32 v61, v79
    v_add_u32 v91, 1040, v91
    v_pk_mul_f32 v[82:83], v[82:83], v[60:61]
    v_pk_fma_f32 v[120:121], v[82:83], v[82:83], v[120:121]
    v_cvt_f64_f32 v[56:57], v82
    v_cvt_f64_f32 v[58:59], v83
    ds_add_f64 v91, v[56:57] offset:41600
    ds_add_f64 v91, v[58:59] offset:41608
    v_mov_b64 v[82:83], 0
K2_EQ14_1:
    s_mov_b64 exec, -1
    s_branch K2_EB14_1
K2_TAILBLOCKS:
K2_MORE:
    v_mov_b32 v16, 1024
    ds_write_b32 v16, v59
    s_branch K2_MOREB
K2_BIG:
    v_mov_b32 v120, 1028
    ds_write_b32 v120, v120
    s_branch K2_BIGB
K2_NEXT:
    v_mov_b32 v123, 1028
    ds_read_b32 v123, v123
    s_add_u32 s24, s24, s25
    s_waitcnt vmcnt(0) lgkmcnt(0)
    v_readfirstlane_b32 s36, v123
    s_barrier
    s_cmp_eq_u32 s36, 0
    s_cbranch_scc1 K2_AGAIN
K2_RESTART:
    s_mov_b32 s68, 1
    s_mov_b32 s70, 1.0
    s_mov_b32 s24, 0
    v_mov_b32 v126, 0
    v_lshlrev_b32 v56, 4, v0
    v_mov_b64 v[8:9], 0
    v_mov_b64 v[10:11], 0
    v_add_u32 v57, 71312, v56
    ds_write_b128 v57, v[8:11]
    ds_write_b128 v57, v[8:11] offset:16384
    s_cmp_ge_u32 s21, 11
    s_cbranch_scc1 K2_RS1
    ds_write_b128 v57, v[8:11] offset:32768
K2_RS1:
    s_waitcnt vmcnt(0) lgkmcnt(0)
    s_branch K2_AGAIN
K2_REDO:
    s_mov_b32 s25, 4
    s_waitcnt vmcnt(0) lgkmcnt(0)
    s_barrier
K2_AGAIN:
    v_lshlrev_b32 v56, 4, v0
    v_mov_b64 v[8:9], 0
    v_mov_b64 v[10:11], 0
    s_cmp_ge_u32 s21, 2
    s_cbranch_scc1 K2_ROUND
    ds_write_b128 v56, v[8:11] offset:0
    s_waitcnt lgkmcnt(0)
K2_LAST:
    s_branch K2_ROUND
K2_GUARDED:
    s_cmp_eq_u32 s35, 10
    s_cbranch_scc1 K2_GT6
    s_cmp_eq_u32 s35, 11
    s_cbranch_scc1 K2_GT5
    s_cmp_eq_u32 s35, 9
    s_cbranch_scc1 K2_GT7
    s_cmp_eq_u32 s35, 12
    s_cbranch_scc1 K2_GT4
    s_cmp_eq_u32 s35, 8
    s_cbranch_scc1 K2_GT8
    s_cmp_eq_u32 s35, 13
    s_cbranch_scc1 K2_GT3
    s_cmp_eq_u32 s35, 7
    s_cbranch_scc1 K2_GT9
    s_cmp_eq_u32 s35, 14
    s_cbranch_scc1 K2_GT2
    s_cmp_eq_u32 s35, 6
    s_cbranch_scc1 K2_GT10
    s_cmp_eq_u32 s35, 15
    s_cbranch_scc1 K2_GT1
    s_cmp_eq_u32 s35, 5
    s_cbranch_scc1 K2_GT11
    s_cmp_eq_u32 s35, 4
    s_cbranch_scc1 K2_GT12
    s_cmp_eq_u32 s35, 3
    s_cbranch_scc1 K2_GT13
    s_cmp_eq_u32 s35, 2
    s_cbranch_scc1 K2_GT14
    s_cmp_eq_u32 s35, 1
    s_cbranch_scc1 K2_GT15
K2_GLOOP:
K2_GT0:
    v_exp_f32 v48, v32
    v_exp_f32 v49, v33
    s_waitcnt vmcnt(0) lgkmcnt(0)
    v_mfma_f32_4x4x4_16b_bf16 v[92:95], v[84:85], v[16:17], v[72:75]
    v_exp_f32 v50, v34
    v_mfma_f32_4x4x4_16b_bf16 v[96:99], v[84:85], v[18:19], v[72:75]
    v_exp_f32 v51, v35
    v_mfma_f32_4x4x4_16b_bf16 v[100:103], v[84:85], v[20:21], v[72:75]
    v_exp_f32 v52, v36
    v_mfma_f32_4x4x4_16b_bf16 v[104:107], v[84:85], v[22:23], v[72:75]
    v_exp_f32 v53, v37
    v_exp_f32 v54, v38
    v_exp_f32 v55, v39
    v_exp_f32 v56, v40
    v_mfma_f32_32x32x16_bf16 v[92:107], v[64:67], v[68:71], v[92:107]
    v_exp_f32 v57, v41
    v_exp_f32 v58, v42
    v_exp_f32 v59, v43
    v_exp_f32 v60, v44
    v_exp_f32 v61, v45
    buffer_load_dword v16, v8, s[8:11], 0 offen
    buffer_load_dword v17, v12, s[8:11], 0 offen
    buffer_load_dword v18, v9, s[8:11], 0 offen
    buffer_load_dword v19, v13, s[8:11], 0 offen
    buffer_load_dword v20, v10, s[8:11], 0 offen
    buffer_load_dword v21, v14, s[8:11], 0 offen
    buffer_load_dword v22, v11, s[8:11], 0 offen
    buffer_load_dword v23, v15, s[8:11], 0 offen
    ds_read_b128 v[8:11], v86 offset:48
    ds_read_b128 v[12:15], v87 offset:48
    ds_read2_b64 v[64:67], v88 offset0:8 offset1:8
    v_exp_f32 v62, v46
    v_exp_f32 v63, v47
    v_pk_fma_f32 v[48:49], v[48:49], s[26:27], s[26:27] op_sel_hi:[1,0,0] clamp
    v_pk_fma_f32 v[50:51], v[50:51], s[26:27], s[26:27] op_sel_hi:[1,0,0] clamp
    v_pk_fma_f32 v[52:53], v[52:53], s[26:27], s[26:27] op_sel_hi:[1,0,0] clamp
    v_pk_fma_f32 v[54:55], v[54:55], s[26:27], s[26:27] op_sel_hi:[1,0,0] clamp
    v_pk_fma_f32 v[56:57], v[56:57], s[26:27], s[26:27] op_sel_hi:[1,0,0] clamp
    v_pk_fma_f32 v[58:59], v[58:59], s[26:27], s[26:27] op_sel_hi:[1,0,0] clamp
    v_pk_fma_f32 v[60:61], v[60:61], s[26:27], s[26:27] op_sel_hi:[1,0,0] clamp
    v_pk_fma_f32 v[62:63], v[62:63], s[26:27], s[26:27] op_sel_hi:[1,0,0] clamp
    v_pk_mul_f32 v[32:33], v[32:33], v[52:53]
    v_pk_mul_f32 v[34:35], v[34:35], v[54:55]
    v_pk_mul_f32 v[40:41], v[40:41], v[60:61]
    v_pk_mul_f32 v[42:43], v[42:43], v[62:63]
    v_pk_fma_f32 v[32:33], v[36:37], v[48:49], v[32:33]
    v_pk_fma_f32 v[34:35], v[38:39], v[50:51], v[34:35]
    v_pk_fma_f32 v[40:41], v[44:45], v[56:57], v[40:41]
    v_pk_fma_f32 v[42:43], v[46:47], v[58:59], v[42:43]
    v_pk_mul_f32 v[48:49], v[48:49], v[52:53]
    v_pk_mul_f32 v[50:51], v[50:51], v[54:55]
    v_pk_mul_f32 v[56:57], v[56:57], v[60:61]
    v_pk_mul_f32 v[58:59], v[58:59], v[62:63]
    v_pk_mul_f32 v[52:53], v[48:49], v[56:57]
    v_pk_mul_f32 v[54:55], v[50:51], v[58:59]
    v_pk_mul_f32 v[32:33], v[32:33], v[56:57]
    v_pk_mul_f32 v[34:35], v[34:35], v[58:59]
    v_rcp_f32 v52, v52
    v_rcp_f32 v54, v54
    v_rcp_f32 v53, v53
    v_rcp_f32 v55, v55
    v_pk_fma_f32 v[32:33], v[40:41], v[48:49], v[32:33]
    v_pk_fma_f32 v[34:35], v[42:43], v[50:51], v[34:35]
    v_pk_fma_f32 v[80:81], v[32:33], v[52:53], v[80:81]
    v_pk_fma_f32 v[82:83], v[34:35], v[54:55], v[82:83]
    s_bitcmp1_b32 s32, 0
    s_cbranch_scc1 K2_GEV0_0
K2_GEB0_0:
    s_bitcmp1_b32 s33, 0
    s_cbranch_scc1 K2_GEV0_1
K2_GEB0_1:
K2_GT1:
    v_exp_f32 v48, v92
    v_exp_f32 v49, v93
    s_waitcnt vmcnt(0) lgkmcnt(0)
    v_mfma_f32_4x4x4_16b_bf16 v[32:35], v[84:85], v[16:17], v[72:75]
    v_exp_f32 v50, v94
    v_mfma_f32_4x4x4_16b_bf16 v[36:39], v[84:85], v[18:19], v[72:75]
    v_exp_f32 v51, v95
    v_mfma_f32_4x4x4_16b_bf16 v[40:43], v[84:85], v[20:21], v[72:75]
    v_exp_f32 v52, v96
    v_mfma_f32_4x4x4_16b_bf16 v[44:47], v[84:85], v[22:23], v[72:75]
    v_exp_f32 v53, v97
    v_exp_f32 v54, v98
    v_exp_f32 v55, v99
    v_exp_f32 v56, v100
    v_mfma_f32_32x32x16_bf16 v[32:47], v[64:67], v[68:71], v[32:47]
    v_exp_f32 v57, v101
    v_exp_f32 v58, v102
    v_exp_f32 v59, v103
    v_exp_f32 v60, v104
    v_exp_f32 v61, v105
    buffer_load_dword v16, v8, s[8:11], 0 offen
    buffer_load_dword v17, v12, s[8:11], 0 offen
    buffer_load_dword v18, v9, s[8:11], 0 offen
    buffer_load_dword v19, v13, s[8:11], 0 offen
    buffer_load_dword v20, v10, s[8:11], 0 offen
    buffer_load_dword v21, v14, s[8:11], 0 offen
    buffer_load_dword v22, v11, s[8:11], 0 offen
    buffer_load_dword v23, v15, s[8:11], 0 offen
    ds_read_b128 v[8:11], v86 offset:64
    ds_read_b128 v[12:15], v87 offset:64
    ds_read2_b64 v[64:67], v88 offset0:12 offset1:12
    v_exp_f32 v62, v106
    v_exp_f32 v63, v107
    v_pk_fma_f32 v[48:49], v[48:49], s[26:27], s[26:27] op_sel_hi:[1,0,0] clamp
    v_pk_fma_f32 v[50:51], v[50:51], s[26:27], s[26:27] op_sel_hi:[1,0,0] clamp
    v_pk_fma_f32 v[52:53], v[52:53], s[26:27], s[26:27] op_sel_hi:[1,0,0] clamp
    v_pk_fma_f32 v[54:55], v[54:55], s[26:27], s[26:27] op_sel_hi:[1,0,0] clamp
    v_pk_fma_f32 v[56:57], v[56:57], s[26:27], s[26:27] op_sel_hi:[1,0,0] clamp
    v_pk_fma_f32 v[58:59], v[58:59], s[26:27], s[26:27] op_sel_hi:[1,0,0] clamp
    v_pk_fma_f32 v[60:61], v[60:61], s[26:27], s[26:27] op_sel_hi:[1,0,0] clamp
    v_pk_fma_f32 v[62:63], v[62:63], s[26:27], s[26:27] op_sel_hi:[1,0,0] clamp
    v_pk_mul_f32 v[92:93], v[92:93], v[52:53]
    v_pk_mul_f32 v[94:95], v[94:95], v[54:55]
    v_pk_mul_f32 v[100:101], v[100:101], v[60:61]
    v_pk_mul_f32 v[102:103], v[102:103], v[62:63]
    v_pk_fma_f32 v[92:93], v[96:97], v[48:49], v[92:93]
    v_pk_fma_f32 v[94:95], v[98:99], v[50:51], v[94:95]
    v_pk_fma_f32 v[100:101], v[104:105], v[56:57], v[100:101]
    v_pk_fma_f32 v[102:103], v[106:107], v[58:59], v[102:103]
    v_pk_mul_f32 v[48:49], v[48:49], v[52:53]
    v_pk_mul_f32 v[50:51], v[50:51], v[54:55]
    v_pk_mul_f32 v[56:57], v[56:57], v[60:61]
    v_pk_mul_f32 v[58:59], v[58:59], v[62:63]
    v_pk_mul_f32 v[52:53], v[48:49], v[56:57]
    v_pk_mul_f32 v[54:55], v[50:51], v[58:59]
    v_pk_mul_f32 v[92:93], v[92:93], v[56:57]
    v_pk_mul_f32 v[94:95], v[94:95], v[58:59]
    v_rcp_f32 v52, v52
    v_rcp_f32 v54, v54
    v_rcp_f32 v53, v53
    v_rcp_f32 v55, v55
    v_pk_fma_f32 v[92:93], v[100:101], v[48:49], v[92:93]
    v_pk_fma_f32 v[94:95], v[102:103], v[50:51], v[94:95]
    v_pk_fma_f32 v[80:81], v[92:93], v[52:53], v[80:81]
    v_pk_fma_f32 v[82:83], v[94:95], v[54:55], v[82:83]
    s_bitcmp1_b32 s32, 1
    s_cbranch_scc1 K2_GEV1_0
K2_GEB1_0:
    s_bitcmp1_b32 s33, 1
    s_cbranch_scc1 K2_GEV1_1
K2_GEB1_1:
K2_GT2:
    v_exp_f32 v48, v32
    v_exp_f32 v49, v33
    s_waitcnt vmcnt(0) lgkmcnt(0)
    v_mfma_f32_4x4x4_16b_bf16 v[92:95], v[84:85], v[16:17], v[72:75]
    v_exp_f32 v50, v34
    v_mfma_f32_4x4x4_16b_bf16 v[96:99], v[84:85], v[18:19], v[72:75]
    v_exp_f32 v51, v35
    v_mfma_f32_4x4x4_16b_bf16 v[100:103], v[84:85], v[20:21], v[72:75]
    v_exp_f32 v52, v36
    v_mfma_f32_4x4x4_16b_bf16 v[104:107], v[84:85], v[22:23], v[72:75]
    v_exp_f32 v53, v37
    v_exp_f32 v54, v38
    v_exp_f32 v55, v39
    v_exp_f32 v56, v40
    v_mfma_f32_32x32x16_bf16 v[92:107], v[64:67], v[68:71], v[92:107]
    v_exp_f32 v57, v41
    v_exp_f32 v58, v42
    v_exp_f32 v59, v43
    v_exp_f32 v60, v44
    v_exp_f32 v61, v45
    buffer_load_dword v16, v8, s[8:11], 0 offen
    buffer_load_dword v17, v12, s[8:11], 0 offen
    buffer_load_dword v18, v9, s[8:11], 0 offen
    buffer_load_dword v19, v13, s[8:11], 0 offen
    buffer_load_dword v20, v10, s[8:11], 0 offen
    buffer_load_dword v21, v14, s[8:11], 0 offen
    buffer_load_dword v22, v11, s[8:11], 0 offen
    buffer_load_dword v23, v15, s[8:11], 0 offen
    ds_read_b128 v[8:11], v86 offset:80
    ds_read_b128 v[12:15], v87 offset:80
    ds_read2_b64 v[64:67], v88 offset0:16 offset1:16
    v_exp_f32 v62, v46
    v_exp_f32 v63, v47
    v_pk_fma_f32 v[48:49], v[48:49], s[26:27], s[26:27] op_sel_hi:[1,0,0] clamp
    v_pk_fma_f32 v[50:51], v[50:51], s[26:27], s[26:27] op_sel_hi:[1,0,0] clamp
    v_pk_fma_f32 v[52:53], v[52:53], s[26:27], s[26:27] op_sel_hi:[1,0,0] clamp
    v_pk_fma_f32 v[54:55], v[54:55], s[26:27], s[26:27] op_sel_hi:[1,0,0] clamp
    v_pk_fma_f32 v[56:57], v[56:57], s[26:27], s[26:27] op_sel_hi:[1,0,0] clamp
    v_pk_fma_f32 v[58:59], v[58:59], s[26:27], s[26:27] op_sel_hi:[1,0,0] clamp
    v_pk_fma_f32 v[60:61], v[60:61], s[26:27], s[26:27] op_sel_hi:[1,0,0] clamp
    v_pk_fma_f32 v[62:63], v[62:63], s[26:27], s[26:27] op_sel_hi:[1,0,0] clamp
    v_pk_mul_f32 v[32:33], v[32:33], v[52:53]
    v_pk_mul_f32 v[34:35], v[34:35], v[54:55]
    v_pk_mul_f32 v[40:41], v[40:41], v[60:61]
    v_pk_mul_f32 v[42:43], v[42:43], v[62:63]
    v_pk_fma_f32 v[32:33], v[36:37], v[48:49], v[32:33]
    v_pk_fma_f32 v[34:35], v[38:39], v[50:51], v[34:35]
    v_pk_fma_f32 v[40:41], v[44:45], v[56:57], v[40:41]
    v_pk_fma_f32 v[42:43], v[46:47], v[58:59], v[42:43]
    v_pk_mul_f32 v[48:49], v[48:49], v[52:53]
    v_pk_mul_f32 v[50:51], v[50:51], v[54:55]
    v_pk_mul_f32 v[56:57], v[56:57], v[60:61]
    v_pk_mul_f32 v[58:59], v[58:59], v[62:63]
    v_pk_mul_f32 v[52:53], v[48:49], v[56:57]
    v_pk_mul_f32 v[54:55], v[50:51], v[58:59]
    v_pk_mul_f32 v[32:33], v[32:33], v[56:57]
    v_pk_mul_f32 v[34:35], v[34:35], v[58:59]
    v_rcp_f32 v52, v52
    v_rcp_f32 v54, v54
    v_rcp_f32 v53, v53
    v_rcp_f32 v55, v55
    v_pk_fma_f32 v[32:33], v[40:41], v[48:49], v[32:33]
    v_pk_fma_f32 v[34:35], v[42:43], v[50:51], v[34:35]
    v_pk_fma_f32 v[80:81], v[32:33], v[52:53], v[80:81]
    v_pk_fma_f32 v[82:83], v[34:35], v[54:55], v[82:83]
    s_bitcmp1_b32 s32, 2
    s_cbranch_scc1 K2_GEV2_0
K2_GEB2_0:
    s_bitcmp1_b32 s33, 2
    s_cbranch_scc1 K2_GEV2_1
K2_GEB2_1:
K2_GT3:
    v_exp_f32 v48, v92
    v_exp_f32 v49, v93
    s_waitcnt vmcnt(0) lgkmcnt(0)
    v_mfma_f32_4x4x4_16b_bf16 v[32:35], v[84:85], v[16:17], v[72:75]
    v_exp_f32 v50, v94
    v_mfma_f32_4x4x4_16b_bf16 v[36:39], v[84:85], v[18:19], v[72:75]
    v_exp_f32 v51, v95
    v_mfma_f32_4x4x4_16b_bf16 v[40:43], v[84:85], v[20:21], v[72:75]
    v_exp_f32 v52, v96
    v_mfma_f32_4x4x4_16b_bf16 v[44:47], v[84:85], v[22:23], v[72:75]
    v_exp_f32 v53, v97
    v_exp_f32 v54, v98
    v_exp_f32 v55, v99
    v_exp_f32 v56, v100
    v_mfma_f32_32x32x16_bf16 v[32:47], v[64:67], v[68:71], v[32:47]
    v_exp_f32 v57, v101
    v_exp_f32 v58, v102
    v_exp_f32 v59, v103
    v_exp_f32 v60, v104
    v_exp_f32 v61, v105
    buffer_load_dword v16, v8, s[8:11], 0 offen
    buffer_load_dword v17, v12, s[8:11], 0 offen
    buffer_load_dword v18, v9, s[8:11], 0 offen
    buffer_load_dword v19, v13, s[8:11], 0 offen
    buffer_load_dword v20, v10, s[8:11], 0 offen
    buffer_load_dword v21, v14, s[8:11], 0 offen
    buffer_load_dword v22, v11, s[8:11], 0 offen
    buffer_load_dword v23, v15, s[8:11], 0 offen
    ds_read_b128 v[8:11], v86 offset:96
    ds_read_b128 v[12:15], v87 offset:96
    ds_read2_b64 v[64:67], v88 offset0:20 offset1:20
    v_exp_f32 v62, v106
    v_exp_f32 v63, v107
    v_pk_fma_f32 v[48:49], v[48:49], s[26:27], s[26:27] op_sel_hi:[1,0,0] clamp
    v_pk_fma_f32 v[50:51], v[50:51], s[26:27], s[26:27] op_sel_hi:[1,0,0] clamp
    v_pk_fma_f32 v[52:53], v[52:53], s[26:27], s[26:27] op_sel_hi:[1,0,0] clamp
    v_pk_fma_f32 v[54:55], v[54:55], s[26:27], s[26:27] op_sel_hi:[1,0,0] clamp
    v_pk_fma_f32 v[56:57], v[56:57], s[26:27], s[26:27] op_sel_hi:[1,0,0] clamp
    v_pk_fma_f32 v[58:59], v[58:59], s[26:27], s[26:27] op_sel_hi:[1,0,0] clamp
    v_pk_fma_f32 v[60:61], v[60:61], s[26:27], s[26:27] op_sel_hi:[1,0,0] clamp
    v_pk_fma_f32 v[62:63], v[62:63], s[26:27], s[26:27] op_sel_hi:[1,0,0] clamp
    v_pk_mul_f32 v[92:93], v[92:93], v[52:53]
    v_pk_mul_f32 v[94:95], v[94:95], v[54:55]
    v_pk_mul_f32 v[100:101], v[100:101], v[60:61]
    v_pk_mul_f32 v[102:103], v[102:103], v[62:63]
    v_pk_fma_f32 v[92:93], v[96:97], v[48:49], v[92:93]
    v_pk_fma_f32 v[94:95], v[98:99], v[50:51], v[94:95]
    v_pk_fma_f32 v[100:101], v[104:105], v[56:57], v[100:101]
    v_pk_fma_f32 v[102:103], v[106:107], v[58:59], v[102:103]
    v_pk_mul_f32 v[48:49], v[48:49], v[52:53]
    v_pk_mul_f32 v[50:51], v[50:51], v[54:55]
    v_pk_mul_f32 v[56:57], v[56:57], v[60:61]
    v_pk_mul_f32 v[58:59], v[58:59], v[62:63]
    v_pk_mul_f32 v[52:53], v[48:49], v[56:57]
    v_pk_mul_f32 v[54:55], v[50:51], v[58:59]
    v_pk_mul_f32 v[92:93], v[92:93], v[56:57]
    v_pk_mul_f32 v[94:95], v[94:95], v[58:59]
    v_rcp_f32 v52, v52
    v_rcp_f32 v54, v54
    v_rcp_f32 v53, v53
    v_rcp_f32 v55, v55
    v_pk_fma_f32 v[92:93], v[100:101], v[48:49], v[92:93]
    v_pk_fma_f32 v[94:95], v[102:103], v[50:51], v[94:95]
    v_pk_fma_f32 v[80:81], v[92:93], v[52:53], v[80:81]
    v_pk_fma_f32 v[82:83], v[94:95], v[54:55], v[82:83]
    s_bitcmp1_b32 s32, 3
    s_cbranch_scc1 K2_GEV3_0
K2_GEB3_0:
    s_bitcmp1_b32 s33, 3
    s_cbranch_scc1 K2_GEV3_1
K2_GEB3_1:
K2_GT4:
    v_exp_f32 v48, v32
    v_exp_f32 v49, v33
    s_waitcnt vmcnt(0) lgkmcnt(0)
    v_mfma_f32_4x4x4_16b_bf16 v[92:95], v[84:85], v[16:17], v[72:75]
    v_exp_f32 v50, v34
    v_mfma_f32_4x4x4_16b_bf16 v[96:99], v[84:85], v[18:19], v[72:75]
    v_exp_f32 v51, v35
    v_mfma_f32_4x4x4_16b_bf16 v[100:103], v[84:85], v[20:21], v[72:75]
    v_exp_f32 v52, v36
    v_mfma_f32_4x4x4_16b_bf16 v[104:107], v[84:85], v[22:23], v[72:75]
    v_exp_f32 v53, v37
    v_exp_f32 v54, v38
    v_exp_f32 v55, v39
    v_exp_f32 v56, v40
    v_mfma_f32_32x32x16_bf16 v[92:107], v[64:67], v[68:71], v[92:107]
    v_exp_f32 v57, v41
    v_exp_f32 v58, v42
    v_exp_f32 v59, v43
    v_exp_f32 v60, v44
    v_exp_f32 v61, v45
    buffer_load_dword v16, v8, s[8:11], 0 offen
    buffer_load_dword v17, v12, s[8:11], 0 offen
    buffer_load_dword v18, v9, s[8:11], 0 offen
    buffer_load_dword v19, v13, s[8:11], 0 offen
    buffer_load_dword v20, v10, s[8:11], 0 offen
    buffer_load_dword v21, v14, s[8:11], 0 offen
    buffer_load_dword v22, v11, s[8:11], 0 offen
    buffer_load_dword v23, v15, s[8:11], 0 offen
    ds_read_b128 v[8:11], v86 offset:112
    ds_read_b128 v[12:15], v87 offset:112
    ds_read2_b64 v[64:67], v88 offset0:24 offset1:24
    v_exp_f32 v62, v46
    v_exp_f32 v63, v47
    v_pk_fma_f32 v[48:49], v[48:49], s[26:27], s[26:27] op_sel_hi:[1,0,0] clamp
    v_pk_fma_f32 v[50:51], v[50:51], s[26:27], s[26:27] op_sel_hi:[1,0,0] clamp
    v_pk_fma_f32 v[52:53], v[52:53], s[26:27], s[26:27] op_sel_hi:[1,0,0] clamp
    v_pk_fma_f32 v[54:55], v[54:55], s[26:27], s[26:27] op_sel_hi:[1,0,0] clamp
    v_pk_fma_f32 v[56:57], v[56:57], s[26:27], s[26:27] op_sel_hi:[1,0,0] clamp
    v_pk_fma_f32 v[58:59], v[58:59], s[26:27], s[26:27] op_sel_hi:[1,0,0] clamp
    v_pk_fma_f32 v[60:61], v[60:61], s[26:27], s[26:27] op_sel_hi:[1,0,0] clamp
    v_pk_fma_f32 v[62:63], v[62:63], s[26:27], s[26:27] op_sel_hi:[1,0,0] clamp
    v_pk_mul_f32 v[32:33], v[32:33], v[52:53]
    v_pk_mul_f32 v[34:35], v[34:35], v[54:55]
    v_pk_mul_f32 v[40:41], v[40:41], v[60:61]
    v_pk_mul_f32 v[42:43], v[42:43], v[62:63]
    v_pk_fma_f32 v[32:33], v[36:37], v[48:49], v[32:33]
    v_pk_fma_f32 v[34:35], v[38:39], v[50:51], v[34:35]
    v_pk_fma_f32 v[40:41], v[44:45], v[56:57], v[40:41]
    v_pk_fma_f32 v[42:43], v[46:47], v[58:59], v[42:43]
    v_pk_mul_f32 v[48:49], v[48:49], v[52:53]
    v_pk_mul_f32 v[50:51], v[50:51], v[54:55]
    v_pk_mul_f32 v[56:57], v[56:57], v[60:61]
    v_pk_mul_f32 v[58:59], v[58:59], v[62:63]
    v_pk_mul_f32 v[52:53], v[48:49], v[56:57]
    v_pk_mul_f32 v[54:55], v[50:51], v[58:59]
    v_pk_mul_f32 v[32:33], v[32:33], v[56:57]
    v_pk_mul_f32 v[34:35], v[34:35], v[58:59]
    v_rcp_f32 v52, v52
    v_rcp_f32 v54, v54
    v_rcp_f32 v53, v53
    v_rcp_f32 v55, v55
    v_pk_fma_f32 v[32:33], v[40:41], v[48:49], v[32:33]
    v_pk_fma_f32 v[34:35], v[42:43], v[50:51], v[34:35]
    v_pk_fma_f32 v[80:81], v[32:33], v[52:53], v[80:81]
    v_pk_fma_f32 v[82:83], v[34:35], v[54:55], v[82:83]
    s_bitcmp1_b32 s32, 4
    s_cbranch_scc1 K2_GEV4_0
K2_GEB4_0:
    s_bitcmp1_b32 s33, 4
    s_cbranch_scc1 K2_GEV4_1
K2_GEB4_1:
K2_GT5:
    v_exp_f32 v48, v92
    v_exp_f32 v49, v93
    s_waitcnt vmcnt(0) lgkmcnt(0)
    v_mfma_f32_4x4x4_16b_bf16 v[32:35], v[84:85], v[16:17], v[72:75]
    v_exp_f32 v50, v94
    v_mfma_f32_4x4x4_16b_bf16 v[36:39], v[84:85], v[18:19], v[72:75]
    v_exp_f32 v51, v95
    v_mfma_f32_4x4x4_16b_bf16 v[40:43], v[84:85], v[20:21], v[72:75]
    v_exp_f32 v52, v96
    v_mfma_f32_4x4x4_16b_bf16 v[44:47], v[84:85], v[22:23], v[72:75]
    v_exp_f32 v53, v97
    v_exp_f32 v54, v98
    v_exp_f32 v55, v99
    v_exp_f32 v56, v100
    v_mfma_f32_32x32x16_bf16 v[32:47], v[64:67], v[68:71], v[32:47]
    v_exp_f32 v57, v101
    v_exp_f32 v58, v102
    v_exp_f32 v59, v103
    v_exp_f32 v60, v104
    v_exp_f32 v61, v105
    buffer_load_dword v16, v8, s[8:11], 0 offen
    buffer_load_dword v17, v12, s[8:11], 0 offen
    buffer_load_dword v18, v9, s[8:11], 0 offen
    buffer_load_dword v19, v13, s[8:11], 0 offen
    buffer_load_dword v20, v10, s[8:11], 0 offen
    buffer_load_dword v21, v14, s[8:11], 0 offen
    buffer_load_dword v22, v11, s[8:11], 0 offen
    buffer_load_dword v23, v15, s[8:11], 0 offen
    ds_read_b128 v[8:11], v86 offset:128
    ds_read_b128 v[12:15], v87 offset:128
    ds_read2_b64 v[64:67], v88 offset0:28 offset1:28
    v_exp_f32 v62, v106
    v_exp_f32 v63, v107
    v_pk_fma_f32 v[48:49], v[48:49], s[26:27], s[26:27] op_sel_hi:[1,0,0] clamp
    v_pk_fma_f32 v[50:51], v[50:51], s[26:27], s[26:27] op_sel_hi:[1,0,0] clamp
    v_pk_fma_f32 v[52:53], v[52:53], s[26:27], s[26:27] op_sel_hi:[1,0,0] clamp
    v_pk_fma_f32 v[54:55], v[54:55], s[26:27], s[26:27] op_sel_hi:[1,0,0] clamp
    v_pk_fma_f32 v[56:57], v[56:57], s[26:27], s[26:27] op_sel_hi:[1,0,0] clamp
    v_pk_fma_f32 v[58:59], v[58:59], s[26:27], s[26:27] op_sel_hi:[1,0,0] clamp
    v_pk_fma_f32 v[60:61], v[60:61], s[26:27], s[26:27] op_sel_hi:[1,0,0] clamp
    v_pk_fma_f32 v[62:63], v[62:63], s[26:27], s[26:27] op_sel_hi:[1,0,0] clamp
    v_pk_mul_f32 v[92:93], v[92:93], v[52:53]
    v_pk_mul_f32 v[94:95], v[94:95], v[54:55]
    v_pk_mul_f32 v[100:101], v[100:101], v[60:61]
    v_pk_mul_f32 v[102:103], v[102:103], v[62:63]
    v_pk_fma_f32 v[92:93], v[96:97], v[48:49], v[92:93]
    v_pk_fma_f32 v[94:95], v[98:99], v[50:51], v[94:95]
    v_pk_fma_f32 v[100:101], v[104:105], v[56:57], v[100:101]
    v_pk_fma_f32 v[102:103], v[106:107], v[58:59], v[102:103]
    v_pk_mul_f32 v[48:49], v[48:49], v[52:53]
    v_pk_mul_f32 v[50:51], v[50:51], v[54:55]
    v_pk_mul_f32 v[56:57], v[56:57], v[60:61]
    v_pk_mul_f32 v[58:59], v[58:59], v[62:63]
    v_pk_mul_f32 v[52:53], v[48:49], v[56:57]
    v_pk_mul_f32 v[54:55], v[50:51], v[58:59]
    v_pk_mul_f32 v[92:93], v[92:93], v[56:57]
    v_pk_mul_f32 v[94:95], v[94:95], v[58:59]
    v_rcp_f32 v52, v52
    v_rcp_f32 v54, v54
    v_rcp_f32 v53, v53
    v_rcp_f32 v55, v55
    v_pk_fma_f32 v[92:93], v[100:101], v[48:49], v[92:93]
    v_pk_fma_f32 v[94:95], v[102:103], v[50:51], v[94:95]
    v_pk_fma_f32 v[80:81], v[92:93], v[52:53], v[80:81]
    v_pk_fma_f32 v[82:83], v[94:95], v[54:55], v[82:83]
    s_bitcmp1_b32 s32, 5
    s_cbranch_scc1 K2_GEV5_0
K2_GEB5_0:
    s_bitcmp1_b32 s33, 5
    s_cbranch_scc1 K2_GEV5_1
K2_GEB5_1:
K2_GT6:
    v_exp_f32 v48, v32
    v_exp_f32 v49, v33
    s_waitcnt vmcnt(0) lgkmcnt(0)
    v_mfma_f32_4x4x4_16b_bf16 v[92:95], v[84:85], v[16:17], v[72:75]
    v_exp_f32 v50, v34
    v_mfma_f32_4x4x4_16b_bf16 v[96:99], v[84:85], v[18:19], v[72:75]
    v_exp_f32 v51, v35
    v_mfma_f32_4x4x4_16b_bf16 v[100:103], v[84:85], v[20:21], v[72:75]
    v_exp_f32 v52, v36
    v_mfma_f32_4x4x4_16b_bf16 v[104:107], v[84:85], v[22:23], v[72:75]
    v_exp_f32 v53, v37
    v_exp_f32 v54, v38
    v_exp_f32 v55, v39
    v_exp_f32 v56, v40
    v_mfma_f32_32x32x16_bf16 v[92:107], v[64:67], v[68:71], v[92:107]
    v_exp_f32 v57, v41
    v_exp_f32 v58, v42
    v_exp_f32 v59, v43
    v_exp_f32 v60, v44
    v_exp_f32 v61, v45
    buffer_load_dword v16, v8, s[8:11], 0 offen
    buffer_load_dword v17, v12, s[8:11], 0 offen
    buffer_load_dword v18, v9, s[8:11], 0 offen
    buffer_load_dword v19, v13, s[8:11], 0 offen
    buffer_load_dword v20, v10, s[8:11], 0 offen
    buffer_load_dword v21, v14, s[8:11], 0 offen
    buffer_load_dword v22, v11, s[8:11], 0 offen
    buffer_load_dword v23, v15, s[8:11], 0 offen
    ds_read_b128 v[8:11], v86 offset:144
    ds_read_b128 v[12:15], v87 offset:144
    ds_read2_b64 v[64:67], v88 offset0:32 offset1:32
    v_exp_f32 v62, v46
    v_exp_f32 v63, v47
    v_pk_fma_f32 v[48:49], v[48:49], s[26:27], s[26:27] op_sel_hi:[1,0,0] clamp
    v_pk_fma_f32 v[50:51], v[50:51], s[26:27], s[26:27] op_sel_hi:[1,0,0] clamp
    v_pk_fma_f32 v[52:53], v[52:53], s[26:27], s[26:27] op_sel_hi:[1,0,0] clamp
    v_pk_fma_f32 v[54:55], v[54:55], s[26:27], s[26:27] op_sel_hi:[1,0,0] clamp
    v_pk_fma_f32 v[56:57], v[56:57], s[26:27], s[26:27] op_sel_hi:[1,0,0] clamp
    v_pk_fma_f32 v[58:59], v[58:59], s[26:27], s[26:27] op_sel_hi:[1,0,0] clamp
    v_pk_fma_f32 v[60:61], v[60:61], s[26:27], s[26:27] op_sel_hi:[1,0,0] clamp
    v_pk_fma_f32 v[62:63], v[62:63], s[26:27], s[26:27] op_sel_hi:[1,0,0] clamp
    v_pk_mul_f32 v[32:33], v[32:33], v[52:53]
    v_pk_mul_f32 v[34:35], v[34:35], v[54:55]
    v_pk_mul_f32 v[40:41], v[40:41], v[60:61]
    v_pk_mul_f32 v[42:43], v[42:43], v[62:63]
    v_pk_fma_f32 v[32:33], v[36:37], v[48:49], v[32:33]
    v_pk_fma_f32 v[34:35], v[38:39], v[50:51], v[34:35]
    v_pk_fma_f32 v[40:41], v[44:45], v[56:57], v[40:41]
    v_pk_fma_f32 v[42:43], v[46:47], v[58:59], v[42:43]
    v_pk_mul_f32 v[48:49], v[48:49], v[52:53]
    v_pk_mul_f32 v[50:51], v[50:51], v[54:55]
    v_pk_mul_f32 v[56:57], v[56:57], v[60:61]
    v_pk_mul_f32 v[58:59], v[58:59], v[62:63]
    v_pk_mul_f32 v[52:53], v[48:49], v[56:57]
    v_pk_mul_f32 v[54:55], v[50:51], v[58:59]
    v_pk_mul_f32 v[32:33], v[32:33], v[56:57]
    v_pk_mul_f32 v[34:35], v[34:35], v[58:59]
    v_rcp_f32 v52, v52
    v_rcp_f32 v54, v54
    v_rcp_f32 v53, v53
    v_rcp_f32 v55, v55
    v_pk_fma_f32 v[32:33], v[40:41], v[48:49], v[32:33]
    v_pk_fma_f32 v[34:35], v[42:43], v[50:51], v[34:35]
    v_pk_fma_f32 v[80:81], v[32:33], v[52:53], v[80:81]
    v_pk_fma_f32 v[82:83], v[34:35], v[54:55], v[82:83]
    s_bitcmp1_b32 s32, 6
    s_cbranch_scc1 K2_GEV6_0
K2_GEB6_0:
    s_bitcmp1_b32 s33, 6
    s_cbranch_scc1 K2_GEV6_1
K2_GEB6_1:
K2_GT7:
    v_exp_f32 v48, v92
    v_exp_f32 v49, v93
    s_waitcnt vmcnt(0) lgkmcnt(0)
    v_mfma_f32_4x4x4_16b_bf16 v[32:35], v[84:85], v[16:17], v[72:75]
    v_exp_f32 v50, v94
    v_mfma_f32_4x4x4_16b_bf16 v[36:39], v[84:85], v[18:19], v[72:75]
    v_exp_f32 v51, v95
    v_mfma_f32_4x4x4_16b_bf16 v[40:43], v[84:85], v[20:21], v[72:75]
    v_exp_f32 v52, v96
    v_mfma_f32_4x4x4_16b_bf16 v[44:47], v[84:85], v[22:23], v[72:75]
    v_exp_f32 v53, v97
    v_exp_f32 v54, v98
    v_exp_f32 v55, v99
    v_exp_f32 v56, v100
    v_mfma_f32_32x32x16_bf16 v[32:47], v[64:67], v[68:71], v[32:47]
    v_exp_f32 v57, v101
    v_exp_f32 v58, v102
    v_exp_f32 v59, v103
    v_exp_f32 v60, v104
    v_exp_f32 v61, v105
    buffer_load_dword v16, v8, s[8:11], 0 offen
    buffer_load_dword v17, v12, s[8:11], 0 offen
    buffer_load_dword v18, v9, s[8:11], 0 offen
    buffer_load_dword v19, v13, s[8:11], 0 offen
    buffer_load_dword v20, v10, s[8:11], 0 offen
    buffer_load_dword v21, v14, s[8:11], 0 offen
    buffer_load_dword v22, v11, s[8:11], 0 offen
    buffer_load_dword v23, v15, s[8:11], 0 offen
    ds_read_b128 v[8:11], v86 offset:160
    ds_read_b128 v[12:15], v87 offset:160
    ds_read2_b64 v[64:67], v88 offset0:36 offset1:36
    v_exp_f32 v62, v106
    v_exp_f32 v63, v107
    v_pk_fma_f32 v[48:49], v[48:49], s[26:27], s[26:27] op_sel_hi:[1,0,0] clamp
    v_pk_fma_f32 v[50:51], v[50:51], s[26:27], s[26:27] op_sel_hi:[1,0,0] clamp
    v_pk_fma_f32 v[52:53], v[52:53], s[26:27], s[26:27] op_sel_hi:[1,0,0] clamp
    v_pk_fma_f32 v[54:55], v[54:55], s[26:27], s[26:27] op_sel_hi:[1,0,0] clamp
    v_pk_fma_f32 v[56:57], v[56:57], s[26:27], s[26:27] op_sel_hi:[1,0,0] clamp
    v_pk_fma_f32 v[58:59], v[58:59], s[26:27], s[26:27] op_sel_hi:[1,0,0] clamp
    v_pk_fma_f32 v[60:61], v[60:61], s[26:27], s[26:27] op_sel_hi:[1,0,0] clamp
    v_pk_fma_f32 v[62:63], v[62:63], s[26:27], s[26:27] op_sel_hi:[1,0,0] clamp
    v_pk_mul_f32 v[92:93], v[92:93], v[52:53]
    v_pk_mul_f32 v[94:95], v[94:95], v[54:55]
    v_pk_mul_f32 v[100:101], v[100:101], v[60:61]
    v_pk_mul_f32 v[102:103], v[102:103], v[62:63]
    v_pk_fma_f32 v[92:93], v[96:97], v[48:49], v[92:93]
    v_pk_fma_f32 v[94:95], v[98:99], v[50:51], v[94:95]
    v_pk_fma_f32 v[100:101], v[104:105], v[56:57], v[100:101]
    v_pk_fma_f32 v[102:103], v[106:107], v[58:59], v[102:103]
    v_pk_mul_f32 v[48:49], v[48:49], v[52:53]
    v_pk_mul_f32 v[50:51], v[50:51], v[54:55]
    v_pk_mul_f32 v[56:57], v[56:57], v[60:61]
    v_pk_mul_f32 v[58:59], v[58:59], v[62:63]
    v_pk_mul_f32 v[52:53], v[48:49], v[56:57]
    v_pk_mul_f32 v[54:55], v[50:51], v[58:59]
    v_pk_mul_f32 v[92:93], v[92:93], v[56:57]
    v_pk_mul_f32 v[94:95], v[94:95], v[58:59]
    v_rcp_f32 v52, v52
    v_rcp_f32 v54, v54
    v_rcp_f32 v53, v53
    v_rcp_f32 v55, v55
    v_pk_fma_f32 v[92:93], v[100:101], v[48:49], v[92:93]
    v_pk_fma_f32 v[94:95], v[102:103], v[50:51], v[94:95]
    v_pk_fma_f32 v[80:81], v[92:93], v[52:53], v[80:81]
    v_pk_fma_f32 v[82:83], v[94:95], v[54:55], v[82:83]
    s_bitcmp1_b32 s32, 7
    s_cbranch_scc1 K2_GEV7_0
K2_GEB7_0:
    s_bitcmp1_b32 s33, 7
    s_cbranch_scc1 K2_GEV7_1
K2_GEB7_1:
K2_GT8:
    v_exp_f32 v48, v32
    v_exp_f32 v49, v33
    s_waitcnt vmcnt(0) lgkmcnt(0)
    v_mfma_f32_4x4x4_16b_bf16 v[92:95], v[84:85], v[16:17], v[72:75]
    v_exp_f32 v50, v34
    v_mfma_f32_4x4x4_16b_bf16 v[96:99], v[84:85], v[18:19], v[72:75]
    v_exp_f32 v51, v35
    v_mfma_f32_4x4x4_16b_bf16 v[100:103], v[84:85], v[20:21], v[72:75]
    v_exp_f32 v52, v36
    v_mfma_f32_4x4x4_16b_bf16 v[104:107], v[84:85], v[22:23], v[72:75]
    v_exp_f32 v53, v37
    v_exp_f32 v54, v38
    v_exp_f32 v55, v39
    v_exp_f32 v56, v40
    v_mfma_f32_32x32x16_bf16 v[92:107], v[64:67], v[68:71], v[92:107]
    v_exp_f32 v57, v41
    v_exp_f32 v58, v42
    v_exp_f32 v59, v43
    v_exp_f32 v60, v44
    v_exp_f32 v61, v45
    buffer_load_dword v16, v8, s[8:11], 0 offen
    buffer_load_dword v17, v12, s[8:11], 0 offen
    buffer_load_dword v18, v9, s[8:11], 0 offen
    buffer_load_dword v19, v13, s[8:11], 0 offen
    buffer_load_dword v20, v10, s[8:11], 0 offen
    buffer_load_dword v21, v14, s[8:11], 0 offen
    buffer_load_dword v22, v11, s[8:11], 0 offen
    buffer_load_dword v23, v15, s[8:11], 0 offen
    ds_read_b128 v[8:11], v86 offset:176
    ds_read_b128 v[12:15], v87 offset:176
    ds_read2_b64 v[64:67], v88 offset0:40 offset1:40
    v_exp_f32 v62, v46
    v_exp_f32 v63, v47
    v_pk_fma_f32 v[48:49], v[48:49], s[26:27], s[26:27] op_sel_hi:[1,0,0] clamp
    v_pk_fma_f32 v[50:51], v[50:51], s[26:27], s[26:27] op_sel_hi:[1,0,0] clamp
    v_pk_fma_f32 v[52:53], v[52:53], s[26:27], s[26:27] op_sel_hi:[1,0,0] clamp
    v_pk_fma_f32 v[54:55], v[54:55], s[26:27], s[26:27] op_sel_hi:[1,0,0] clamp
    v_pk_fma_f32 v[56:57], v[56:57], s[26:27], s[26:27] op_sel_hi:[1,0,0] clamp
    v_pk_fma_f32 v[58:59], v[58:59], s[26:27], s[26:27] op_sel_hi:[1,0,0] clamp
    v_pk_fma_f32 v[60:61], v[60:61], s[26:27], s[26:27] op_sel_hi:[1,0,0] clamp
    v_pk_fma_f32 v[62:63], v[62:63], s[26:27], s[26:27] op_sel_hi:[1,0,0] clamp
    v_pk_mul_f32 v[32:33], v[32:33], v[52:53]
    v_pk_mul_f32 v[34:35], v[34:35], v[54:55]
    v_pk_mul_f32 v[40:41], v[40:41], v[60:61]
    v_pk_mul_f32 v[42:43], v[42:43], v[62:63]
    v_pk_fma_f32 v[32:33], v[36:37], v[48:49], v[32:33]
    v_pk_fma_f32 v[34:35], v[38:39], v[50:51], v[34:35]
    v_pk_fma_f32 v[40:41], v[44:45], v[56:57], v[40:41]
    v_pk_fma_f32 v[42:43], v[46:47], v[58:59], v[42:43]
    v_pk_mul_f32 v[48:49], v[48:49], v[52:53]
    v_pk_mul_f32 v[50:51], v[50:51], v[54:55]
    v_pk_mul_f32 v[56:57], v[56:57], v[60:61]
    v_pk_mul_f32 v[58:59], v[58:59], v[62:63]
    v_pk_mul_f32 v[52:53], v[48:49], v[56:57]
    v_pk_mul_f32 v[54:55], v[50:51], v[58:59]
    v_pk_mul_f32 v[32:33], v[32:33], v[56:57]
    v_pk_mul_f32 v[34:35], v[34:35], v[58:59]
    v_rcp_f32 v52, v52
    v_rcp_f32 v54, v54
    v_rcp_f32 v53, v53
    v_rcp_f32 v55, v55
    v_pk_fma_f32 v[32:33], v[40:41], v[48:49], v[32:33]
    v_pk_fma_f32 v[34:35], v[42:43], v[50:51], v[34:35]
    v_pk_fma_f32 v[80:81], v[32:33], v[52:53], v[80:81]
    v_pk_fma_f32 v[82:83], v[34:35], v[54:55], v[82:83]
    s_bitcmp1_b32 s32, 8
    s_cbranch_scc1 K2_GEV8_0
K2_GEB8_0:
    s_bitcmp1_b32 s33, 8
    s_cbranch_scc1 K2_GEV8_1
K2_GEB8_1:
K2_GT9:
    v_exp_f32 v48, v92
    v_exp_f32 v49, v93
    s_waitcnt vmcnt(0) lgkmcnt(0)
    v_mfma_f32_4x4x4_16b_bf16 v[32:35], v[84:85], v[16:17], v[72:75]
    v_exp_f32 v50, v94
    v_mfma_f32_4x4x4_16b_bf16 v[36:39], v[84:85], v[18:19], v[72:75]
    v_exp_f32 v51, v95
    v_mfma_f32_4x4x4_16b_bf16 v[40:43], v[84:85], v[20:21], v[72:75]
    v_exp_f32 v52, v96
    v_mfma_f32_4x4x4_16b_bf16 v[44:47], v[84:85], v[22:23], v[72:75]
    v_exp_f32 v53, v97
    v_exp_f32 v54, v98
    v_exp_f32 v55, v99
    v_exp_f32 v56, v100
    v_mfma_f32_32x32x16_bf16 v[32:47], v[64:67], v[68:71], v[32:47]
    v_exp_f32 v57, v101
    v_exp_f32 v58, v102
    v_exp_f32 v59, v103
    v_exp_f32 v60, v104
    v_exp_f32 v61, v105
    buffer_load_dword v16, v8, s[8:11], 0 offen
    buffer_load_dword v17, v12, s[8:11], 0 offen
    buffer_load_dword v18, v9, s[8:11], 0 offen
    buffer_load_dword v19, v13, s[8:11], 0 offen
    buffer_load_dword v20, v10, s[8:11], 0 offen
    buffer_load_dword v21, v14, s[8:11], 0 offen
    buffer_load_dword v22, v11, s[8:11], 0 offen
    buffer_load_dword v23, v15, s[8:11], 0 offen
    ds_read_b128 v[8:11], v86 offset:192
    ds_read_b128 v[12:15], v87 offset:192
    ds_read2_b64 v[64:67], v88 offset0:44 offset1:44
    v_exp_f32 v62, v106
    v_exp_f32 v63, v107
    v_pk_fma_f32 v[48:49], v[48:49], s[26:27], s[26:27] op_sel_hi:[1,0,0] clamp
    v_pk_fma_f32 v[50:51], v[50:51], s[26:27], s[26:27] op_sel_hi:[1,0,0] clamp
    v_pk_fma_f32 v[52:53], v[52:53], s[26:27], s[26:27] op_sel_hi:[1,0,0] clamp
    v_pk_fma_f32 v[54:55], v[54:55], s[26:27], s[26:27] op_sel_hi:[1,0,0] clamp
    v_pk_fma_f32 v[56:57], v[56:57], s[26:27], s[26:27] op_sel_hi:[1,0,0] clamp
    v_pk_fma_f32 v[58:59], v[58:59], s[26:27], s[26:27] op_sel_hi:[1,0,0] clamp
    v_pk_fma_f32 v[60:61], v[60:61], s[26:27], s[26:27] op_sel_hi:[1,0,0] clamp
    v_pk_fma_f32 v[62:63], v[62:63], s[26:27], s[26:27] op_sel_hi:[1,0,0] clamp
    v_pk_mul_f32 v[92:93], v[92:93], v[52:53]
    v_pk_mul_f32 v[94:95], v[94:95], v[54:55]
    v_pk_mul_f32 v[100:101], v[100:101], v[60:61]
    v_pk_mul_f32 v[102:103], v[102:103], v[62:63]
    v_pk_fma_f32 v[92:93], v[96:97], v[48:49], v[92:93]
    v_pk_fma_f32 v[94:95], v[98:99], v[50:51], v[94:95]
    v_pk_fma_f32 v[100:101], v[104:105], v[56:57], v[100:101]
    v_pk_fma_f32 v[102:103], v[106:107], v[58:59], v[102:103]
    v_pk_mul_f32 v[48:49], v[48:49], v[52:53]
    v_pk_mul_f32 v[50:51], v[50:51], v[54:55]
    v_pk_mul_f32 v[56:57], v[56:57], v[60:61]
    v_pk_mul_f32 v[58:59], v[58:59], v[62:63]
    v_pk_mul_f32 v[52:53], v[48:49], v[56:57]
    v_pk_mul_f32 v[54:55], v[50:51], v[58:59]
    v_pk_mul_f32 v[92:93], v[92:93], v[56:57]
    v_pk_mul_f32 v[94:95], v[94:95], v[58:59]
    v_rcp_f32 v52, v52
    v_rcp_f32 v54, v54
    v_rcp_f32 v53, v53
    v_rcp_f32 v55, v55
    v_pk_fma_f32 v[92:93], v[100:101], v[48:49], v[92:93]
    v_pk_fma_f32 v[94:95], v[102:103], v[50:51], v[94:95]
    v_pk_fma_f32 v[80:81], v[92:93], v[52:53], v[80:81]
    v_pk_fma_f32 v[82:83], v[94:95], v[54:55], v[82:83]
    s_bitcmp1_b32 s32, 9
    s_cbranch_scc1 K2_GEV9_0
K2_GEB9_0:
    s_bitcmp1_b32 s33, 9
    s_cbranch_scc1 K2_GEV9_1
K2_GEB9_1:
K2_GT10:
    v_exp_f32 v48, v32
    v_exp_f32 v49, v33
    s_waitcnt vmcnt(0) lgkmcnt(0)
    v_mfma_f32_4x4x4_16b_bf16 v[92:95], v[84:85], v[16:17], v[72:75]
    v_exp_f32 v50, v34
    v_mfma_f32_4x4x4_16b_bf16 v[96:99], v[84:85], v[18:19], v[72:75]
    v_exp_f32 v51, v35
    v_mfma_f32_4x4x4_16b_bf16 v[100:103], v[84:85], v[20:21], v[72:75]
    v_exp_f32 v52, v36
    v_mfma_f32_4x4x4_16b_bf16 v[104:107], v[84:85], v[22:23], v[72:75]
    v_exp_f32 v53, v37
    v_exp_f32 v54, v38
    v_exp_f32 v55, v39
    v_exp_f32 v56, v40
    v_mfma_f32_32x32x16_bf16 v[92:107], v[64:67], v[68:71], v[92:107]
    v_exp_f32 v57, v41
    v_exp_f32 v58, v42
    v_exp_f32 v59, v43
    v_exp_f32 v60, v44
    v_exp_f32 v61, v45
    buffer_load_dword v16, v8, s[8:11], 0 offen
    buffer_load_dword v17, v12, s[8:11], 0 offen
    buffer_load_dword v18, v9, s[8:11], 0 offen
    buffer_load_dword v19, v13, s[8:11], 0 offen
    buffer_load_dword v20, v10, s[8:11], 0 offen
    buffer_load_dword v21, v14, s[8:11], 0 offen
    buffer_load_dword v22, v11, s[8:11], 0 offen
    buffer_load_dword v23, v15, s[8:11], 0 offen
    ds_read_b128 v[8:11], v86 offset:208
    ds_read_b128 v[12:15], v87 offset:208
    ds_read2_b64 v[64:67], v88 offset0:48 offset1:48
    v_exp_f32 v62, v46
    v_exp_f32 v63, v47
    v_pk_fma_f32 v[48:49], v[48:49], s[26:27], s[26:27] op_sel_hi:[1,0,0] clamp
    v_pk_fma_f32 v[50:51], v[50:51], s[26:27], s[26:27] op_sel_hi:[1,0,0] clamp
    v_pk_fma_f32 v[52:53], v[52:53], s[26:27], s[26:27] op_sel_hi:[1,0,0] clamp
    v_pk_fma_f32 v[54:55], v[54:55], s[26:27], s[26:27] op_sel_hi:[1,0,0] clamp
    v_pk_fma_f32 v[56:57], v[56:57], s[26:27], s[26:27] op_sel_hi:[1,0,0] clamp
    v_pk_fma_f32 v[58:59], v[58:59], s[26:27], s[26:27] op_sel_hi:[1,0,0] clamp
    v_pk_fma_f32 v[60:61], v[60:61], s[26:27], s[26:27] op_sel_hi:[1,0,0] clamp
    v_pk_fma_f32 v[62:63], v[62:63], s[26:27], s[26:27] op_sel_hi:[1,0,0] clamp
    v_pk_mul_f32 v[32:33], v[32:33], v[52:53]
    v_pk_mul_f32 v[34:35], v[34:35], v[54:55]
    v_pk_mul_f32 v[40:41], v[40:41], v[60:61]
    v_pk_mul_f32 v[42:43], v[42:43], v[62:63]
    v_pk_fma_f32 v[32:33], v[36:37], v[48:49], v[32:33]
    v_pk_fma_f32 v[34:35], v[38:39], v[50:51], v[34:35]
    v_pk_fma_f32 v[40:41], v[44:45], v[56:57], v[40:41]
    v_pk_fma_f32 v[42:43], v[46:47], v[58:59], v[42:43]
    v_pk_mul_f32 v[48:49], v[48:49], v[52:53]
    v_pk_mul_f32 v[50:51], v[50:51], v[54:55]
    v_pk_mul_f32 v[56:57], v[56:57], v[60:61]
    v_pk_mul_f32 v[58:59], v[58:59], v[62:63]
    v_pk_mul_f32 v[52:53], v[48:49], v[56:57]
    v_pk_mul_f32 v[54:55], v[50:51], v[58:59]
    v_pk_mul_f32 v[32:33], v[32:33], v[56:57]
    v_pk_mul_f32 v[34:35], v[34:35], v[58:59]
    v_rcp_f32 v52, v52
    v_rcp_f32 v54, v54
    v_rcp_f32 v53, v53
    v_rcp_f32 v55, v55
    v_pk_fma_f32 v[32:33], v[40:41], v[48:49], v[32:33]
    v_pk_fma_f32 v[34:35], v[42:43], v[50:51], v[34:35]
    v_pk_fma_f32 v[80:81], v[32:33], v[52:53], v[80:81]
    v_pk_fma_f32 v[82:83], v[34:35], v[54:55], v[82:83]
    s_bitcmp1_b32 s32, 10
    s_cbranch_scc1 K2_GEV10_0
K2_GEB10_0:
    s_bitcmp1_b32 s33, 10
    s_cbranch_scc1 K2_GEV10_1
K2_GEB10_1:
K2_GT11:
    v_exp_f32 v48, v92
    v_exp_f32 v49, v93
    s_waitcnt vmcnt(0) lgkmcnt(0)
    v_mfma_f32_4x4x4_16b_bf16 v[32:35], v[84:85], v[16:17], v[72:75]
    v_exp_f32 v50, v94
    v_mfma_f32_4x4x4_16b_bf16 v[36:39], v[84:85], v[18:19], v[72:75]
    v_exp_f32 v51, v95
    v_mfma_f32_4x4x4_16b_bf16 v[40:43], v[84:85], v[20:21], v[72:75]
    v_exp_f32 v52, v96
    v_mfma_f32_4x4x4_16b_bf16 v[44:47], v[84:85], v[22:23], v[72:75]
    v_exp_f32 v53, v97
    v_exp_f32 v54, v98
    v_exp_f32 v55, v99
    v_exp_f32 v56, v100
    v_mfma_f32_32x32x16_bf16 v[32:47], v[64:67], v[68:71], v[32:47]
    v_exp_f32 v57, v101
    v_exp_f32 v58, v102
    v_exp_f32 v59, v103
    v_exp_f32 v60, v104
    v_exp_f32 v61, v105
    buffer_load_dword v16, v8, s[8:11], 0 offen
    buffer_load_dword v17, v12, s[8:11], 0 offen
    buffer_load_dword v18, v9, s[8:11], 0 offen
    buffer_load_dword v19, v13, s[8:11], 0 offen
    buffer_load_dword v20, v10, s[8:11], 0 offen
    buffer_load_dword v21, v14, s[8:11], 0 offen
    buffer_load_dword v22, v11, s[8:11], 0 offen
    buffer_load_dword v23, v15, s[8:11], 0 offen
    ds_read_b128 v[8:11], v86 offset:224
    ds_read_b128 v[12:15], v87 offset:224
    ds_read2_b64 v[64:67], v88 offset0:52 offset1:52
    v_exp_f32 v62, v106
    v_exp_f32 v63, v107
    v_pk_fma_f32 v[48:49], v[48:49], s[26:27], s[26:27] op_sel_hi:[1,0,0] clamp
    v_pk_fma_f32 v[50:51], v[50:51], s[26:27], s[26:27] op_sel_hi:[1,0,0] clamp
    v_pk_fma_f32 v[52:53], v[52:53], s[26:27], s[26:27] op_sel_hi:[1,0,0] clamp
    v_pk_fma_f32 v[54:55], v[54:55], s[26:27], s[26:27] op_sel_hi:[1,0,0] clamp
    v_pk_fma_f32 v[56:57], v[56:57], s[26:27], s[26:27] op_sel_hi:[1,0,0] clamp
    v_pk_fma_f32 v[58:59], v[58:59], s[26:27], s[26:27] op_sel_hi:[1,0,0] clamp
    v_pk_fma_f32 v[60:61], v[60:61], s[26:27], s[26:27] op_sel_hi:[1,0,0] clamp
    v_pk_fma_f32 v[62:63], v[62:63], s[26:27], s[26:27] op_sel_hi:[1,0,0] clamp
    v_pk_mul_f32 v[92:93], v[92:93], v[52:53]
    v_pk_mul_f32 v[94:95], v[94:95], v[54:55]
    v_pk_mul_f32 v[100:101], v[100:101], v[60:61]
    v_pk_mul_f32 v[102:103], v[102:103], v[62:63]
    v_pk_fma_f32 v[92:93], v[96:97], v[48:49], v[92:93]
    v_pk_fma_f32 v[94:95], v[98:99], v[50:51], v[94:95]
    v_pk_fma_f32 v[100:101], v[104:105], v[56:57], v[100:101]
    v_pk_fma_f32 v[102:103], v[106:107], v[58:59], v[102:103]
    v_pk_mul_f32 v[48:49], v[48:49], v[52:53]
    v_pk_mul_f32 v[50:51], v[50:51], v[54:55]
    v_pk_mul_f32 v[56:57], v[56:57], v[60:61]
    v_pk_mul_f32 v[58:59], v[58:59], v[62:63]
    v_pk_mul_f32 v[52:53], v[48:49], v[56:57]
    v_pk_mul_f32 v[54:55], v[50:51], v[58:59]
    v_pk_mul_f32 v[92:93], v[92:93], v[56:57]
    v_pk_mul_f32 v[94:95], v[94:95], v[58:59]
    v_rcp_f32 v52, v52
    v_rcp_f32 v54, v54
    v_rcp_f32 v53, v53
    v_rcp_f32 v55, v55
    v_pk_fma_f32 v[92:93], v[100:101], v[48:49], v[92:93]
    v_pk_fma_f32 v[94:95], v[102:103], v[50:51], v[94:95]
    v_pk_fma_f32 v[80:81], v[92:93], v[52:53], v[80:81]
    v_pk_fma_f32 v[82:83], v[94:95], v[54:55], v[82:83]
    s_bitcmp1_b32 s32, 11
    s_cbranch_scc1 K2_GEV11_0
K2_GEB11_0:
    s_bitcmp1_b32 s33, 11
    s_cbranch_scc1 K2_GEV11_1
K2_GEB11_1:
K2_GT12:
    s_setprio 1
    v_exp_f32 v48, v32
    v_exp_f32 v49, v33
    s_waitcnt vmcnt(0) lgkmcnt(0)
    v_mfma_f32_4x4x4_16b_bf16 v[92:95], v[84:85], v[16:17], v[72:75]
    v_exp_f32 v50, v34
    v_mfma_f32_4x4x4_16b_bf16 v[96:99], v[84:85], v[18:19], v[72:75]
    v_exp_f32 v51, v35
    v_mfma_f32_4x4x4_16b_bf16 v[100:103], v[84:85], v[20:21], v[72:75]
    v_exp_f32 v52, v36
    v_mfma_f32_4x4x4_16b_bf16 v[104:107], v[84:85], v[22:23], v[72:75]
    v_exp_f32 v53, v37
    v_exp_f32 v54, v38
    v_exp_f32 v55, v39
    v_exp_f32 v56, v40
    v_mfma_f32_32x32x16_bf16 v[92:107], v[64:67], v[68:71], v[92:107]
    v_exp_f32 v57, v41
    v_exp_f32 v58, v42
    v_exp_f32 v59, v43
    v_exp_f32 v60, v44
    v_exp_f32 v61, v45
    buffer_load_dword v16, v8, s[8:11], 0 offen
    buffer_load_dword v17, v12, s[8:11], 0 offen
    buffer_load_dword v18, v9, s[8:11], 0 offen
    buffer_load_dword v19, v13, s[8:11], 0 offen
    buffer_load_dword v20, v10, s[8:11], 0 offen
    buffer_load_dword v21, v14, s[8:11], 0 offen
    buffer_load_dword v22, v11, s[8:11], 0 offen
    buffer_load_dword v23, v15, s[8:11], 0 offen
    ds_read_b128 v[8:11], v86 offset:240
    ds_read_b128 v[12:15], v87 offset:240
    ds_read2_b64 v[64:67], v88 offset0:56 offset1:56
    v_exp_f32 v62, v46
    v_exp_f32 v63, v47
    v_pk_fma_f32 v[48:49], v[48:49], s[26:27], s[26:27] op_sel_hi:[1,0,0] clamp
    v_pk_fma_f32 v[50:51], v[50:51], s[26:27], s[26:27] op_sel_hi:[1,0,0] clamp
    v_pk_fma_f32 v[52:53], v[52:53], s[26:27], s[26:27] op_sel_hi:[1,0,0] clamp
    v_pk_fma_f32 v[54:55], v[54:55], s[26:27], s[26:27] op_sel_hi:[1,0,0] clamp
    v_pk_fma_f32 v[56:57], v[56:57], s[26:27], s[26:27] op_sel_hi:[1,0,0] clamp
    v_pk_fma_f32 v[58:59], v[58:59], s[26:27], s[26:27] op_sel_hi:[1,0,0] clamp
    v_pk_fma_f32 v[60:61], v[60:61], s[26:27], s[26:27] op_sel_hi:[1,0,0] clamp
    v_pk_fma_f32 v[62:63], v[62:63], s[26:27], s[26:27] op_sel_hi:[1,0,0] clamp
    v_pk_mul_f32 v[32:33], v[32:33], v[52:53]
    v_pk_mul_f32 v[34:35], v[34:35], v[54:55]
    v_pk_mul_f32 v[40:41], v[40:41], v[60:61]
    v_pk_mul_f32 v[42:43], v[42:43], v[62:63]
    v_pk_fma_f32 v[32:33], v[36:37], v[48:49], v[32:33]
    v_pk_fma_f32 v[34:35], v[38:39], v[50:51], v[34:35]
    v_pk_fma_f32 v[40:41], v[44:45], v[56:57], v[40:41]
    v_pk_fma_f32 v[42:43], v[46:47], v[58:59], v[42:43]
    v_pk_mul_f32 v[48:49], v[48:49], v[52:53]
    v_pk_mul_f32 v[50:51], v[50:51], v[54:55]
    v_pk_mul_f32 v[56:57], v[56:57], v[60:61]
    v_pk_mul_f32 v[58:59], v[58:59], v[62:63]
    v_pk_mul_f32 v[52:53], v[48:49], v[56:57]
    v_pk_mul_f32 v[54:55], v[50:51], v[58:59]
    v_pk_mul_f32 v[32:33], v[32:33], v[56:57]
    v_pk_mul_f32 v[34:35], v[34:35], v[58:59]
    v_rcp_f32 v52, v52
    v_rcp_f32 v54, v54
    v_rcp_f32 v53, v53
    v_rcp_f32 v55, v55
    v_pk_fma_f32 v[32:33], v[40:41], v[48:49], v[32:33]
    v_pk_fma_f32 v[34:35], v[42:43], v[50:51], v[34:35]
    v_pk_fma_f32 v[80:81], v[32:33], v[52:53], v[80:81]
    v_pk_fma_f32 v[82:83], v[34:35], v[54:55], v[82:83]
    s_bitcmp1_b32 s32, 12
    s_cbranch_scc1 K2_GEV12_0
K2_GEB12_0:
    s_bitcmp1_b32 s33, 12
    s_cbranch_scc1 K2_GEV12_1
K2_GEB12_1:
K2_GT13:
    v_exp_f32 v48, v92
    v_exp_f32 v49, v93
    s_waitcnt vmcnt(0) lgkmcnt(0)
    v_mfma_f32_4x4x4_16b_bf16 v[32:35], v[84:85], v[16:17], v[72:75]
    v_exp_f32 v50, v94
    v_mfma_f32_4x4x4_16b_bf16 v[36:39], v[84:85], v[18:19], v[72:75]
    v_exp_f32 v51, v95
    v_mfma_f32_4x4x4_16b_bf16 v[40:43], v[84:85], v[20:21], v[72:75]
    v_exp_f32 v52, v96
    v_mfma_f32_4x4x4_16b_bf16 v[44:47], v[84:85], v[22:23], v[72:75]
    v_exp_f32 v53, v97
    v_exp_f32 v54, v98
    v_exp_f32 v55, v99
    v_exp_f32 v56, v100
    v_mfma_f32_32x32x16_bf16 v[32:47], v[64:67], v[68:71], v[32:47]
    v_exp_f32 v57, v101
    v_exp_f32 v58, v102
    v_exp_f32 v59, v103
    v_exp_f32 v60, v104
    v_exp_f32 v61, v105
    buffer_load_dword v16, v8, s[8:11], 0 offen
    buffer_load_dword v17, v12, s[8:11], 0 offen
    buffer_load_dword v18, v9, s[8:11], 0 offen
    buffer_load_dword v19, v13, s[8:11], 0 offen
    buffer_load_dword v20, v10, s[8:11], 0 offen
    buffer_load_dword v21, v14, s[8:11], 0 offen
    buffer_load_dword v22, v11, s[8:11], 0 offen
    buffer_load_dword v23, v15, s[8:11], 0 offen
    ds_read2_b64 v[64:67], v88 offset0:60 offset1:60
    v_exp_f32 v62, v106
    v_exp_f32 v63, v107
    v_pk_fma_f32 v[48:49], v[48:49], s[26:27], s[26:27] op_sel_hi:[1,0,0] clamp
    v_pk_fma_f32 v[50:51], v[50:51], s[26:27], s[26:27] op_sel_hi:[1,0,0] clamp
    v_pk_fma_f32 v[52:53], v[52:53], s[26:27], s[26:27] op_sel_hi:[1,0,0] clamp
    v_pk_fma_f32 v[54:55], v[54:55], s[26:27], s[26:27] op_sel_hi:[1,0,0] clamp
    v_pk_fma_f32 v[56:57], v[56:57], s[26:27], s[26:27] op_sel_hi:[1,0,0] clamp
    v_pk_fma_f32 v[58:59], v[58:59], s[26:27], s[26:27] op_sel_hi:[1,0,0] clamp
    v_pk_fma_f32 v[60:61], v[60:61], s[26:27], s[26:27] op_sel_hi:[1,0,0] clamp
    v_pk_fma_f32 v[62:63], v[62:63], s[26:27], s[26:27] op_sel_hi:[1,0,0] clamp
    v_pk_mul_f32 v[92:93], v[92:93], v[52:53]
    v_pk_mul_f32 v[94:95], v[94:95], v[54:55]
    v_pk_mul_f32 v[100:101], v[100:101], v[60:61]
    v_pk_mul_f32 v[102:103], v[102:103], v[62:63]
    v_pk_fma_f32 v[92:93], v[96:97], v[48:49], v[92:93]
    v_pk_fma_f32 v[94:95], v[98:99], v[50:51], v[94:95]
    v_pk_fma_f32 v[100:101], v[104:105], v[56:57], v[100:101]
    v_pk_fma_f32 v[102:103], v[106:107], v[58:59], v[102:103]
    v_pk_mul_f32 v[48:49], v[48:49], v[52:53]
    v_pk_mul_f32 v[50:51], v[50:51], v[54:55]
    v_pk_mul_f32 v[56:57], v[56:57], v[60:61]
    v_pk_mul_f32 v[58:59], v[58:59], v[62:63]
    v_pk_mul_f32 v[52:53], v[48:49], v[56:57]
    v_pk_mul_f32 v[54:55], v[50:51], v[58:59]
    v_pk_mul_f32 v[92:93], v[92:93], v[56:57]
    v_pk_mul_f32 v[94:95], v[94:95], v[58:59]
    v_rcp_f32 v52, v52
    v_rcp_f32 v54, v54
    v_rcp_f32 v53, v53
    v_rcp_f32 v55, v55
    v_pk_fma_f32 v[92:93], v[100:101], v[48:49], v[92:93]
    v_pk_fma_f32 v[94:95], v[102:103], v[50:51], v[94:95]
    v_pk_fma_f32 v[80:81], v[92:93], v[52:53], v[80:81]
    v_pk_fma_f32 v[82:83], v[94:95], v[54:55], v[82:83]
    s_bitcmp1_b32 s32, 13
    s_cbranch_scc1 K2_GEV13_0
K2_GEB13_0:
    s_bitcmp1_b32 s33, 13
    s_cbranch_scc1 K2_GEV13_1
K2_GEB13_1:
K2_GT14:
    v_exp_f32 v48, v32
    v_exp_f32 v49, v33
    s_waitcnt vmcnt(0) lgkmcnt(0)
    v_mfma_f32_4x4x4_16b_bf16 v[92:95], v[84:85], v[16:17], v[72:75]
    v_exp_f32 v50, v34
    v_mfma_f32_4x4x4_16b_bf16 v[96:99], v[84:85], v[18:19], v[72:75]
    v_exp_f32 v51, v35
    v_mfma_f32_4x4x4_16b_bf16 v[100:103], v[84:85], v[20:21], v[72:75]
    v_exp_f32 v52, v36
    v_mfma_f32_4x4x4_16b_bf16 v[104:107], v[84:85], v[22:23], v[72:75]
    v_exp_f32 v53, v37
    v_exp_f32 v54, v38
    v_exp_f32 v55, v39
    v_exp_f32 v56, v40
    v_mfma_f32_32x32x16_bf16 v[92:107], v[64:67], v[68:71], v[92:107]
    v_exp_f32 v57, v41
    v_exp_f32 v58, v42
    v_exp_f32 v59, v43
    v_exp_f32 v60, v44
    v_exp_f32 v61, v45
    v_exp_f32 v62, v46
    v_exp_f32 v63, v47
    v_pk_fma_f32 v[48:49], v[48:49], s[26:27], s[26:27] op_sel_hi:[1,0,0] clamp
    v_pk_fma_f32 v[50:51], v[50:51], s[26:27], s[26:27] op_sel_hi:[1,0,0] clamp
    v_pk_fma_f32 v[52:53], v[52:53], s[26:27], s[26:27] op_sel_hi:[1,0,0] clamp
    v_pk_fma_f32 v[54:55], v[54:55], s[26:27], s[26:27] op_sel_hi:[1,0,0] clamp
    v_pk_fma_f32 v[56:57], v[56:57], s[26:27], s[26:27] op_sel_hi:[1,0,0] clamp
    v_pk_fma_f32 v[58:59], v[58:59], s[26:27], s[26:27] op_sel_hi:[1,0,0] clamp
    v_pk_fma_f32 v[60:61], v[60:61], s[26:27], s[26:27] op_sel_hi:[1,0,0] clamp
    v_pk_fma_f32 v[62:63], v[62:63], s[26:27], s[26:27] op_sel_hi:[1,0,0] clamp
    v_pk_mul_f32 v[32:33], v[32:33], v[52:53]
    v_pk_mul_f32 v[34:35], v[34:35], v[54:55]
    v_pk_mul_f32 v[40:41], v[40:41], v[60:61]
    v_pk_mul_f32 v[42:43], v[42:43], v[62:63]
    v_pk_fma_f32 v[32:33], v[36:37], v[48:49], v[32:33]
    v_pk_fma_f32 v[34:35], v[38:39], v[50:51], v[34:35]
    v_pk_fma_f32 v[40:41], v[44:45], v[56:57], v[40:41]
    v_pk_fma_f32 v[42:43], v[46:47], v[58:59], v[42:43]
    v_pk_mul_f32 v[48:49], v[48:49], v[52:53]
    v_pk_mul_f32 v[50:51], v[50:51], v[54:55]
    v_pk_mul_f32 v[56:57], v[56:57], v[60:61]
    v_pk_mul_f32 v[58:59], v[58:59], v[62:63]
    v_pk_mul_f32 v[52:53], v[48:49], v[56:57]
    v_pk_mul_f32 v[54:55], v[50:51], v[58:59]
    v_pk_mul_f32 v[32:33], v[32:33], v[56:57]
    v_pk_mul_f32 v[34:35], v[34:35], v[58:59]
    v_rcp_f32 v52, v52
    v_rcp_f32 v54, v54
    v_rcp_f32 v53, v53
    v_rcp_f32 v55, v55
    v_pk_fma_f32 v[32:33], v[40:41], v[48:49], v[32:33]
    v_pk_fma_f32 v[34:35], v[42:43], v[50:51], v[34:35]
    v_pk_fma_f32 v[80:81], v[32:33], v[52:53], v[80:81]
    v_pk_fma_f32 v[82:83], v[34:35], v[54:55], v[82:83]
    s_bitcmp1_b32 s32, 14
    s_cbranch_scc1 K2_GEV14_0
K2_GEB14_0:
    s_bitcmp1_b32 s33, 14
    s_cbranch_scc1 K2_GEV14_1
K2_GEB14_1:
K2_GT15:
    s_setprio 0
    v_exp_f32 v48, v92
    v_exp_f32 v49, v93
    v_exp_f32 v50, v94
    v_exp_f32 v51, v95
    v_exp_f32 v52, v96
    v_exp_f32 v53, v97
    v_exp_f32 v54, v98
    v_exp_f32 v55, v99
    v_exp_f32 v56, v100
    v_exp_f32 v57, v101
    v_exp_f32 v58, v102
    v_exp_f32 v59, v103
    v_exp_f32 v60, v104
    v_exp_f32 v61, v105
    v_exp_f32 v62, v106
    v_exp_f32 v63, v107
    v_pk_fma_f32 v[48:49], v[48:49], s[26:27], s[26:27] op_sel_hi:[1,0,0] clamp
    v_pk_fma_f32 v[50:51], v[50:51], s[26:27], s[26:27] op_sel_hi:[1,0,0] clamp
    v_pk_fma_f32 v[52:53], v[52:53], s[26:27], s[26:27] op_sel_hi:[1,0,0] clamp
    v_pk_fma_f32 v[54:55], v[54:55], s[26:27], s[26:27] op_sel_hi:[1,0,0] clamp
    v_pk_fma_f32 v[56:57], v[56:57], s[26:27], s[26:27] op_sel_hi:[1,0,0] clamp
    v_pk_fma_f32 v[58:59], v[58:59], s[26:27], s[26:27] op_sel_hi:[1,0,0] clamp
    v_pk_fma_f32 v[60:61], v[60:61], s[26:27], s[26:27] op_sel_hi:[1,0,0] clamp
    v_pk_fma_f32 v[62:63], v[62:63], s[26:27], s[26:27] op_sel_hi:[1,0,0] clamp
    v_pk_mul_f32 v[92:93], v[92:93], v[52:53]
    v_pk_mul_f32 v[94:95], v[94:95], v[54:55]
    v_pk_mul_f32 v[100:101], v[100:101], v[60:61]
    v_pk_mul_f32 v[102:103], v[102:103], v[62:63]
    v_pk_fma_f32 v[92:93], v[96:97], v[48:49], v[92:93]
    v_pk_fma_f32 v[94:95], v[98:99], v[50:51], v[94:95]
    v_pk_fma_f32 v[100:101], v[104:105], v[56:57], v[100:101]
    v_pk_fma_f32 v[102:103], v[106:107], v[58:59], v[102:103]
    v_pk_mul_f32 v[48:49], v[48:49], v[52:53]
    v_pk_mul_f32 v[50:51], v[50:51], v[54:55]
    v_pk_mul_f32 v[56:57], v[56:57], v[60:61]
    v_pk_mul_f32 v[58:59], v[58:59], v[62:63]
    v_pk_mul_f32 v[52:53], v[48:49], v[56:57]
    v_pk_mul_f32 v[54:55], v[50:51], v[58:59]
    v_pk_mul_f32 v[92:93], v[92:93], v[56:57]
    v_pk_mul_f32 v[94:95], v[94:95], v[58:59]
    v_rcp_f32 v52, v52
    v_rcp_f32 v54, v54
    v_rcp_f32 v53, v53
    v_rcp_f32 v55, v55
    v_pk_fma_f32 v[92:93], v[100:101], v[48:49], v[92:93]
    v_pk_fma_f32 v[94:95], v[102:103], v[50:51], v[94:95]
    v_pk_fma_f32 v[80:81], v[92:93], v[52:53], v[80:81]
    v_pk_fma_f32 v[82:83], v[94:95], v[54:55], v[82:83]
    s_branch K2_LDONE
K2_GEV0_0:
    s_bfe_i32 exec_lo, s28, 0x10000
    s_bfe_i32 exec_hi, s29, 0x10000
    s_cbranch_execz K2_GEQ0_0
    v_cvt_f64_f32 v[48:49], v80
    v_cvt_f64_f32 v[50:51], v81
    ds_add_f64 v90, v[48:49] offset:42640
    ds_add_f64 v90, v[50:51] offset:42648
    v_add_u32 v90, 1040, v90
    v_mov_b64 v[80:81], 0
K2_GEQ0_0:
    s_bfe_i32 exec_lo, s28, 0x10001
    s_bfe_i32 exec_hi, s29, 0x10001
    ds_read_b64 v[72:73], v90 offset:1040
    s_mov_b64 exec, -1
    s_branch K2_GEB0_0
K2_GEV0_1:
    s_bfe_i32 exec_lo, s30, 0x10000
    s_bfe_i32 exec_hi, s31, 0x10000
    s_cbranch_execz K2_GEQ0_1
    v_cvt_f64_f32 v[56:57], v82
    v_cvt_f64_f32 v[58:59], v83
    ds_add_f64 v91, v[56:57] offset:42640
    ds_add_f64 v91, v[58:59] offset:42648
    v_add_u32 v91, 1040, v91
    v_mov_b64 v[82:83], 0
K2_GEQ0_1:
    s_bfe_i32 exec_lo, s30, 0x10001
    s_bfe_i32 exec_hi, s31, 0x10001
    ds_read_b64 v[74:75], v91 offset:1040
    s_mov_b64 exec, -1
    s_branch K2_GEB0_1
K2_GEV1_0:
    s_bfe_i32 exec_lo, s28, 0x10001
    s_bfe_i32 exec_hi, s29, 0x10001
    s_cbranch_execz K2_GEQ1_0
    v_cvt_f64_f32 v[48:49], v80
    v_cvt_f64_f32 v[50:51], v81
    ds_add_f64 v90, v[48:49] offset:42640
    ds_add_f64 v90, v[50:51] offset:42648
    v_add_u32 v90, 1040, v90
    v_mov_b64 v[80:81], 0
K2_GEQ1_0:
    s_bfe_i32 exec_lo, s28, 0x10002
    s_bfe_i32 exec_hi, s29, 0x10002
    ds_read_b64 v[72:73], v90 offset:1040
    s_mov_b64 exec, -1
    s_branch K2_GEB1_0
K2_GEV1_1:
    s_bfe_i32 exec_lo, s30, 0x10001
    s_bfe_i32 exec_hi, s31, 0x10001
    s_cbranch_execz K2_GEQ1_1
    v_cvt_f64_f32 v[56:57], v82
    v_cvt_f64_f32 v[58:59], v83
    ds_add_f64 v91, v[56:57] offset:42640
    ds_add_f64 v91, v[58:59] offset:42648
    v_add_u32 v91, 1040, v91
    v_mov_b64 v[82:83], 0
K2_GEQ1_1:
    s_bfe_i32 exec_lo, s30, 0x10002
    s_bfe_i32 exec_hi, s31, 0x10002
    ds_read_b64 v[74:75], v91 offset:1040
    s_mov_b64 exec, -1
    s_branch K2_GEB1_1
K2_GEV2_0:
    s_bfe_i32 exec_lo, s28, 0x10002
    s_bfe_i32 exec_hi, s29, 0x10002
    s_cbranch_execz K2_GEQ2_0
    v_cvt_f64_f32 v[48:49], v80
    v_cvt_f64_f32 v[50:51], v81
    ds_add_f64 v90, v[48:49] offset:42640
    ds_add_f64 v90, v[50:51] offset:42648
    v_add_u32 v90, 1040, v90
    v_mov_b64 v[80:81], 0
K2_GEQ2_0:
    s_bfe_i32 exec_lo, s28, 0x10003
    s_bfe_i32 exec_hi, s29, 0x10003
    ds_read_b64 v[72:73], v90 offset:1040
    s_mov_b64 exec, -1
    s_branch K2_GEB2_0
K2_GEV2_1:
    s_bfe_i32 exec_lo, s30, 0x10002
    s_bfe_i32 exec_hi, s31, 0x10002
    s_cbranch_execz K2_GEQ2_1
    v_cvt_f64_f32 v[56:57], v82
    v_cvt_f64_f32 v[58:59], v83
    ds_add_f64 v91, v[56:57] offset:42640
    ds_add_f64 v91, v[58:59] offset:42648
    v_add_u32 v91, 1040, v91
    v_mov_b64 v[82:83], 0
K2_GEQ2_1:
    s_bfe_i32 exec_lo, s30, 0x10003
    s_bfe_i32 exec_hi, s31, 0x10003
    ds_read_b64 v[74:75], v91 offset:1040
    s_mov_b64 exec, -1
    s_branch K2_GEB2_1
K2_GEV3_0:
    s_bfe_i32 exec_lo, s28, 0x10003
    s_bfe_i32 exec_hi, s29, 0x10003
    s_cbranch_execz K2_GEQ3_0
    v_cvt_f64_f32 v[48:49], v80
    v_cvt_f64_f32 v[50:51], v81
    ds_add_f64 v90, v[48:49] offset:42640
    ds_add_f64 v90, v[50:51] offset:42648
    v_add_u32 v90, 1040, v90
    v_mov_b64 v[80:81], 0
K2_GEQ3_0:
    s_bfe_i32 exec_lo, s28, 0x10004
    s_bfe_i32 exec_hi, s29, 0x10004
    ds_read_b64 v[72:73], v90 offset:1040
    s_mov_b64 exec, -1
    s_branch K2_GEB3_0
K2_GEV3_1:
    s_bfe_i32 exec_lo, s30, 0x10003
    s_bfe_i32 exec_hi, s31, 0x10003
    s_cbranch_execz K2_GEQ3_1
    v_cvt_f64_f32 v[56:57], v82
    v_cvt_f64_f32 v[58:59], v83
    ds_add_f64 v91, v[56:57] offset:42640
    ds_add_f64 v91, v[58:59] offset:42648
    v_add_u32 v91, 1040, v91
    v_mov_b64 v[82:83], 0
K2_GEQ3_1:
    s_bfe_i32 exec_lo, s30, 0x10004
    s_bfe_i32 exec_hi, s31, 0x10004
    ds_read_b64 v[74:75], v91 offset:1040
    s_mov_b64 exec, -1
    s_branch K2_GEB3_1
K2_GEV4_0:
    s_bfe_i32 exec_lo, s28, 0x10004
    s_bfe_i32 exec_hi, s29, 0x10004
    s_cbranch_execz K2_GEQ4_0
    v_cvt_f64_f32 v[48:49], v80
    v_cvt_f64_f32 v[50:51], v81
    ds_add_f64 v90, v[48:49] offset:42640
    ds_add_f64 v90, v[50:51] offset:42648
    v_add_u32 v90, 1040, v90
    v_mov_b64 v[80:81], 0
K2_GEQ4_0:
    s_bfe_i32 exec_lo, s28, 0x10005
    s_bfe_i32 exec_hi, s29, 0x10005
    ds_read_b64 v[72:73], v90 offset:1040
    s_mov_b64 exec, -1
    s_branch K2_GEB4_0
K2_GEV4_1:
    s_bfe_i32 exec_lo, s30, 0x10004
    s_bfe_i32 exec_hi, s31, 0x10004
    s_cbranch_execz K2_GEQ4_1
    v_cvt_f64_f32 v[56:57], v82
    v_cvt_f64_f32 v[58:59], v83
    ds_add_f64 v91, v[56:57] offset:42640
    ds_add_f64 v91, v[58:59] offset:42648
    v_add_u32 v91, 1040, v91
    v_mov_b64 v[82:83], 0
K2_GEQ4_1:
    s_bfe_i32 exec_lo, s30, 0x10005
    s_bfe_i32 exec_hi, s31, 0x10005
    ds_read_b64 v[74:75], v91 offset:1040
    s_mov_b64 exec, -1
    s_branch K2_GEB4_1
K2_GEV5_0:
    s_bfe_i32 exec_lo, s28, 0x10005
    s_bfe_i32 exec_hi, s29, 0x10005
    s_cbranch_execz K2_GEQ5_0
    v_cvt_f64_f32 v[48:49], v80
    v_cvt_f64_f32 v[50:51], v81
    ds_add_f64 v90, v[48:49] offset:42640
    ds_add_f64 v90, v[50:51] offset:42648
    v_add_u32 v90, 1040, v90
    v_mov_b64 v[80:81], 0
K2_GEQ5_0:
    s_bfe_i32 exec_lo, s28, 0x10006
    s_bfe_i32 exec_hi, s29, 0x10006
    ds_read_b64 v[72:73], v90 offset:1040
    s_mov_b64 exec, -1
    s_branch K2_GEB5_0
K2_GEV5_1:
    s_bfe_i32 exec_lo, s30, 0x10005
    s_bfe_i32 exec_hi, s31, 0x10005
    s_cbranch_execz K2_GEQ5_1
    v_cvt_f64_f32 v[56:57], v82
    v_cvt_f64_f32 v[58:59], v83
    ds_add_f64 v91, v[56:57] offset:42640
    ds_add_f64 v91, v[58:59] offset:42648
    v_add_u32 v91, 1040, v91
    v_mov_b64 v[82:83], 0
K2_GEQ5_1:
    s_bfe_i32 exec_lo, s30, 0x10006
    s_bfe_i32 exec_hi, s31, 0x10006
    ds_read_b64 v[74:75], v91 offset:1040
    s_mov_b64 exec, -1
    s_branch K2_GEB5_1
K2_GEV6_0:
    s_bfe_i32 exec_lo, s28, 0x10006
    s_bfe_i32 exec_hi, s29, 0x10006
    s_cbranch_execz K2_GEQ6_0
    v_cvt_f64_f32 v[48:49], v80
    v_cvt_f64_f32 v[50:51], v81
    ds_add_f64 v90, v[48:49] offset:42640
    ds_add_f64 v90, v[50:51] offset:42648
    v_add_u32 v90, 1040, v90
    v_mov_b64 v[80:81], 0
K2_GEQ6_0:
    s_bfe_i32 exec_lo, s28, 0x10007
    s_bfe_i32 exec_hi, s29, 0x10007
    ds_read_b64 v[72:73], v90 offset:1040
    s_mov_b64 exec, -1
    s_branch K2_GEB6_0
K2_GEV6_1:
    s_bfe_i32 exec_lo, s30, 0x10006
    s_bfe_i32 exec_hi, s31, 0x10006
    s_cbranch_execz K2_GEQ6_1
    v_cvt_f64_f32 v[56:57], v82
    v_cvt_f64_f32 v[58:59], v83
    ds_add_f64 v91, v[56:57] offset:42640
    ds_add_f64 v91, v[58:59] offset:42648
    v_add_u32 v91, 1040, v91
    v_mov_b64 v[82:83], 0
K2_GEQ6_1:
    s_bfe_i32 exec_lo, s30, 0x10007
    s_bfe_i32 exec_hi, s31, 0x10007
    ds_read_b64 v[74:75], v91 offset:1040
    s_mov_b64 exec, -1
    s_branch K2_GEB6_1
K2_GEV7_0:
    s_bfe_i32 exec_lo, s28, 0x10007
    s_bfe_i32 exec_hi, s29, 0x10007
    s_cbranch_execz K2_GEQ7_0
    v_cvt_f64_f32 v[48:49], v80
    v_cvt_f64_f32 v[50:51], v81
    ds_add_f64 v90, v[48:49] offset:42640
    ds_add_f64 v90, v[50:51] offset:42648
    v_add_u32 v90, 1040, v90
    v_mov_b64 v[80:81], 0
K2_GEQ7_0:
    s_bfe_i32 exec_lo, s28, 0x10008
    s_bfe_i32 exec_hi, s29, 0x10008
    ds_read_b64 v[72:73], v90 offset:1040
    s_mov_b64 exec, -1
    s_branch K2_GEB7_0
K2_GEV7_1:
    s_bfe_i32 exec_lo, s30, 0x10007
    s_bfe_i32 exec_hi, s31, 0x10007
    s_cbranch_execz K2_GEQ7_1
    v_cvt_f64_f32 v[56:57], v82
    v_cvt_f64_f32 v[58:59], v83
    ds_add_f64 v91, v[56:57] offset:42640
    ds_add_f64 v91, v[58:59] offset:42648
    v_add_u32 v91, 1040, v91
    v_mov_b64 v[82:83], 0
K2_GEQ7_1:
    s_bfe_i32 exec_lo, s30, 0x10008
    s_bfe_i32 exec_hi, s31, 0x10008
    ds_read_b64 v[74:75], v91 offset:1040
    s_mov_b64 exec, -1
    s_branch K2_GEB7_1
K2_GEV8_0:
    s_bfe_i32 exec_lo, s28, 0x10008
    s_bfe_i32 exec_hi, s29, 0x10008
    s_cbranch_execz K2_GEQ8_0
    v_cvt_f64_f32 v[48:49], v80
    v_cvt_f64_f32 v[50:51], v81
    ds_add_f64 v90, v[48:49] offset:42640
    ds_add_f64 v90, v[50:51] offset:42648
    v_add_u32 v90, 1040, v90
    v_mov_b64 v[80:81], 0
K2_GEQ8_0:
    s_bfe_i32 exec_lo, s28, 0x10009
    s_bfe_i32 exec_hi, s29, 0x10009
    ds_read_b64 v[72:73], v90 offset:1040
    s_mov_b64 exec, -1
    s_branch K2_GEB8_0
K2_GEV8_1:
    s_bfe_i32 exec_lo, s30, 0x10008
    s_bfe_i32 exec_hi, s31, 0x10008
    s_cbranch_execz K2_GEQ8_1
    v_cvt_f64_f32 v[56:57], v82
    v_cvt_f64_f32 v[58:59], v83
    ds_add_f64 v91, v[56:57] offset:42640
    ds_add_f64 v91, v[58:59] offset:42648
    v_add_u32 v91, 1040, v91
    v_mov_b64 v[82:83], 0
K2_GEQ8_1:
    s_bfe_i32 exec_lo, s30, 0x10009
    s_bfe_i32 exec_hi, s31, 0x10009
    ds_read_b64 v[74:75], v91 offset:1040
    s_mov_b64 exec, -1
    s_branch K2_GEB8_1
K2_GEV9_0:
    s_bfe_i32 exec_lo, s28, 0x10009
    s_bfe_i32 exec_hi, s29, 0x10009
    s_cbranch_execz K2_GEQ9_0
    v_cvt_f64_f32 v[48:49], v80
    v_cvt_f64_f32 v[50:51], v81
    ds_add_f64 v90, v[48:49] offset:42640
    ds_add_f64 v90, v[50:51] offset:42648
    v_add_u32 v90, 1040, v90
    v_mov_b64 v[80:81], 0
K2_GEQ9_0:
    s_bfe_i32 exec_lo, s28, 0x1000a
    s_bfe_i32 exec_hi, s29, 0x1000a
    ds_read_b64 v[72:73], v90 offset:1040
    s_mov_b64 exec, -1
    s_branch K2_GEB9_0
K2_GEV9_1:
    s_bfe_i32 exec_lo, s30, 0x10009
    s_bfe_i32 exec_hi, s31, 0x10009
    s_cbranch_execz K2_GEQ9_1
    v_cvt_f64_f32 v[56:57], v82
    v_cvt_f64_f32 v[58:59], v83
    ds_add_f64 v91, v[56:57] offset:42640
    ds_add_f64 v91, v[58:59] offset:42648
    v_add_u32 v91, 1040, v91
    v_mov_b64 v[82:83], 0
K2_GEQ9_1:
    s_bfe_i32 exec_lo, s30, 0x1000a
    s_bfe_i32 exec_hi, s31, 0x1000a
    ds_read_b64 v[74:75], v91 offset:1040
    s_mov_b64 exec, -1
    s_branch K2_GEB9_1
K2_GEV10_0:
    s_bfe_i32 exec_lo, s28, 0x1000a
    s_bfe_i32 exec_hi, s29, 0x1000a
    s_cbranch_execz K2_GEQ10_0
    v_cvt_f64_f32 v[48:49], v80
    v_cvt_f64_f32 v[50:51], v81
    ds_add_f64 v90, v[48:49] offset:42640
    ds_add_f64 v90, v[50:51] offset:42648
    v_add_u32 v90, 1040, v90
    v_mov_b64 v[80:81], 0
K2_GEQ10_0:
    s_bfe_i32 exec_lo, s28, 0x1000b
    s_bfe_i32 exec_hi, s29, 0x1000b
    ds_read_b64 v[72:73], v90 offset:1040
    s_mov_b64 exec, -1
    s_branch K2_GEB10_0
K2_GEV10_1:
    s_bfe_i32 exec_lo, s30, 0x1000a
    s_bfe_i32 exec_hi, s31, 0x1000a
    s_cbranch_execz K2_GEQ10_1
    v_cvt_f64_f32 v[56:57], v82
    v_cvt_f64_f32 v[58:59], v83
    ds_add_f64 v91, v[56:57] offset:42640
    ds_add_f64 v91, v[58:59] offset:42648
    v_add_u32 v91, 1040, v91
    v_mov_b64 v[82:83], 0
K2_GEQ10_1:
    s_bfe_i32 exec_lo, s30, 0x1000b
    s_bfe_i32 exec_hi, s31, 0x1000b
    ds_read_b64 v[74:75], v91 offset:1040
    s_mov_b64 exec, -1
    s_branch K2_GEB10_1
K2_GEV11_0:
    s_bfe_i32 exec_lo, s28, 0x1000b
    s_bfe_i32 exec_hi, s29, 0x1000b
    s_cbranch_execz K2_GEQ11_0
    v_cvt_f64_f32 v[48:49], v80
    v_cvt_f64_f32 v[50:51], v81
    ds_add_f64 v90, v[48:49] offset:42640
    ds_add_f64 v90, v[50:51] offset:42648
    v_add_u32 v90, 1040, v90
    v_mov_b64 v[80:81], 0
K2_GEQ11_0:
    s_bfe_i32 exec_lo, s28, 0x1000c
    s_bfe_i32 exec_hi, s29, 0x1000c
    ds_read_b64 v[72:73], v90 offset:1040
    s_mov_b64 exec, -1
    s_branch K2_GEB11_0
K2_GEV11_1:
    s_bfe_i32 exec_lo, s30, 0x1000b
    s_bfe_i32 exec_hi, s31, 0x1000b
    s_cbranch_execz K2_GEQ11_1
    v_cvt_f64_f32 v[56:57], v82
    v_cvt_f64_f32 v[58:59], v83
    ds_add_f64 v91, v[56:57] offset:42640
    ds_add_f64 v91, v[58:59] offset:42648
    v_add_u32 v91, 1040, v91
    v_mov_b64 v[82:83], 0
K2_GEQ11_1:
    s_bfe_i32 exec_lo, s30, 0x1000c
    s_bfe_i32 exec_hi, s31, 0x1000c
    ds_read_b64 v[74:75], v91 offset:1040
    s_mov_b64 exec, -1
    s_branch K2_GEB11_1
K2_GEV12_0:
    s_bfe_i32 exec_lo, s28, 0x1000c
    s_bfe_i32 exec_hi, s29, 0x1000c
    s_cbranch_execz K2_GEQ12_0
    v_cvt_f64_f32 v[48:49], v80
    v_cvt_f64_f32 v[50:51], v81
    ds_add_f64 v90, v[48:49] offset:42640
    ds_add_f64 v90, v[50:51] offset:42648
    v_add_u32 v90, 1040, v90
    v_mov_b64 v[80:81], 0
K2_GEQ12_0:
    s_bfe_i32 exec_lo, s28, 0x1000d
    s_bfe_i32 exec_hi, s29, 0x1000d
    ds_read_b64 v[72:73], v90 offset:1040
    s_mov_b64 exec, -1
    s_branch K2_GEB12_0
K2_GEV12_1:
    s_bfe_i32 exec_lo, s30, 0x1000c
    s_bfe_i32 exec_hi, s31, 0x1000c
    s_cbranch_execz K2_GEQ12_1
    v_cvt_f64_f32 v[56:57], v82
    v_cvt_f64_f32 v[58:59], v83
    ds_add_f64 v91, v[56:57] offset:42640
    ds_add_f64 v91, v[58:59] offset:42648
    v_add_u32 v91, 1040, v91
    v_mov_b64 v[82:83], 0
K2_GEQ12_1:
    s_bfe_i32 exec_lo, s30, 0x1000d
    s_bfe_i32 exec_hi, s31, 0x1000d
    ds_read_b64 v[74:75], v91 offset:1040
    s_mov_b64 exec, -1
    s_branch K2_GEB12_1
K2_GEV13_0:
    s_bfe_i32 exec_lo, s28, 0x1000d
    s_bfe_i32 exec_hi, s29, 0x1000d
    s_cbranch_execz K2_GEQ13_0
    v_cvt_f64_f32 v[48:49], v80
    v_cvt_f64_f32 v[50:51], v81
    ds_add_f64 v90, v[48:49] offset:42640
    ds_add_f64 v90, v[50:51] offset:42648
    v_add_u32 v90, 1040, v90
    v_mov_b64 v[80:81], 0
K2_GEQ13_0:
    s_bfe_i32 exec_lo, s28, 0x1000e
    s_bfe_i32 exec_hi, s29, 0x1000e
    ds_read_b64 v[72:73], v90 offset:1040
    s_mov_b64 exec, -1
    s_branch K2_GEB13_0
K2_GEV13_1:
    s_bfe_i32 exec_lo, s30, 0x1000d
    s_bfe_i32 exec_hi, s31, 0x1000d
    s_cbranch_execz K2_GEQ13_1
    v_cvt_f64_f32 v[56:57], v82
    v_cvt_f64_f32 v[58:59], v83
    ds_add_f64 v91, v[56:57] offset:42640
    ds_add_f64 v91, v[58:59] offset:42648
    v_add_u32 v91, 1040, v91
    v_mov_b64 v[82:83], 0
K2_GEQ13_1:
    s_bfe_i32 exec_lo, s30, 0x1000e
    s_bfe_i32 exec_hi, s31, 0x1000e
    ds_read_b64 v[74:75], v91 offset:1040
    s_mov_b64 exec, -1
    s_branch K2_GEB13_1
K2_GEV14_0:
    s_bfe_i32 exec_lo, s28, 0x1000e
    s_bfe_i32 exec_hi, s29, 0x1000e
    s_cbranch_execz K2_GEQ14_0
    v_cvt_f64_f32 v[48:49], v80
    v_cvt_f64_f32 v[50:51], v81
    ds_add_f64 v90, v[48:49] offset:42640
    ds_add_f64 v90, v[50:51] offset:42648
    v_add_u32 v90, 1040, v90
    v_mov_b64 v[80:81], 0
K2_GEQ14_0:
    s_mov_b64 exec, -1
    s_branch K2_GEB14_0
K2_GEV14_1:
    s_bfe_i32 exec_lo, s30, 0x1000e
    s_bfe_i32 exec_hi, s31, 0x1000e
    s_cbranch_execz K2_GEQ14_1
    v_cvt_f64_f32 v[56:57], v82
    v_cvt_f64_f32 v[58:59], v83
    ds_add_f64 v91, v[56:57] offset:42640
    ds_add_f64 v91, v[58:59] offset:42648
    v_add_u32 v91, 1040, v91
    v_mov_b64 v[82:83], 0
K2_GEQ14_1:
    s_mov_b64 exec, -1
    s_branch K2_GEB14_1
.section .rodata,"a"
.p2align 6
.amdhsa_kernel mpnn_bin_kernel
  .amdhsa_next_free_vgpr 80
  .amdhsa_next_free_sgpr 96
  .amdhsa_accum_offset 80
  .amdhsa_group_segment_fixed_size 0
  .amdhsa_kernarg_size 72
  .amdhsa_user_sgpr_count 2
  .amdhsa_user_sgpr_kernarg_segment_ptr 1
  .amdhsa_system_sgpr_workgroup_id_x 1
.end_amdhsa_kernel
.p2align 6
.amdhsa_kernel mpnn_edge_kernel
  .amdhsa_next_free_vgpr 128
  .amdhsa_next_free_sgpr 96
  .amdhsa_accum_offset 128
  .amdhsa_group_segment_fixed_size 0
  .amdhsa_kernarg_size 72
  .amdhsa_user_sgpr_count 2
  .amdhsa_user_sgpr_kernarg_segment_ptr 1
  .amdhsa_system_sgpr_workgroup_id_x 1
.end_amdhsa_kernel
```
